```python
import torch

def _softmax(x, axis=-1):
    return torch.softmax(x, dim=axis)
def _gelu(x):
    return torch.nn.functional.gelu(x, approximate="tanh")
def _silu(x):
    return torch.nn.functional.silu(x)
def _sigmoid(x):
    return torch.sigmoid(x)
def _layernorm(x, axis=-1, eps=1e-5):
    m = x.mean(dim=axis, keepdim=True)
    v = x.var(dim=axis, keepdim=True, unbiased=False)
    return (x - m) / torch.sqrt(v + eps)
def _scatter_add(tgt, idx, src, axis=0):
    return tgt.clone().index_add_(axis, idx, src)
def _segment_sum(src, seg, n):
    out = torch.zeros((n,) + src.shape[1:], dtype=src.dtype)
    return out.index_add_(0, seg, src)
def _pad(x, pw):
    flat = tuple(v for pair in reversed(pw) for v in pair)
    return torch.nn.functional.pad(x, flat)

kernel_name = 'interleave_layers__gqa_block_cached__dense_activation_silu__decode'

def setup_inputs():

    _w = (lambda a: (lambda t: t.to(torch.bfloat16) if t.is_floating_point() else t)(torch.as_tensor(a)))
    def _A_setup():
        B, Sq, D = 2, 1, 512
        Hq, Hkv, Sk, Dh = 32, 8, 8192, 128
        assert Hq % Hkv == 0, (Hq, Hkv)
        return {
            "x": _w((lambda *s: torch.randn(*s, dtype=torch.bfloat16) * 0.1)(B, Sq, D)),
            "k_cache": _w((lambda *s: torch.randn(*s, dtype=torch.bfloat16) * 0.8)(B, Hkv, Sk, Dh)),
            "v_cache": _w((lambda *s: torch.randn(*s, dtype=torch.bfloat16) * 3.2)(B, Hkv, Sk, Dh)),
            "wq": _w((lambda *s: torch.randn(*s, dtype=torch.bfloat16) * 0.8)(D, Hq * Dh) * (D ** -0.5)),
            "wo": _w((lambda *s: torch.randn(*s, dtype=torch.bfloat16) * 3.2)(Hq * Dh, D) * ((Hq * Dh) ** -0.5)),
        }
    _A_in = _A_setup()

    def _B_setup():
        B, S, D, F = 2, 1, 512, 1792
        return {
            "x": _w((lambda *s: torch.randn(*s, dtype=torch.bfloat16) * 0.1)(B, S, D)),
            "w1": _w((lambda *s: torch.randn(*s, dtype=torch.bfloat16) * 1.6)(D, F) * (D ** -0.5)),
            "w2": _w((lambda *s: torch.randn(*s, dtype=torch.bfloat16) * 0.4)(F, D) * (F ** -0.5)),
        }
    _B_in = _B_setup()

    return {
        "A_x": _A_in["x"],
        "A_k_cache": _A_in["k_cache"],
        "A_v_cache": _A_in["v_cache"],
        "A_wq": _A_in["wq"],
        "A_wo": _A_in["wo"],
        "B_x": _B_in["x"],
        "B_w1": _B_in["w1"],
        "B_w2": _B_in["w2"],
    }

def reference(A_x, A_k_cache, A_v_cache, A_wq, A_wo, B_x, B_w1, B_w2):
    def _A_ref(x, k_cache, v_cache, wq, wo):
        B, Sq, D = x.shape
        Hq, Dh = 32, 128
        Hkv = k_cache.shape[1]
        rep = Hq // Hkv
        q = (lambda x, *d: x.permute(*d))((x @ wq).reshape(B, Sq, Hq, Dh), 0, 2, 1, 3)
        k = (lambda x, n, axis: torch.repeat_interleave(x, n, dim=axis))(k_cache, rep, axis=1)
        v = (lambda x, n, axis: torch.repeat_interleave(x, n, dim=axis))(v_cache, rep, axis=1)
        scores = torch.einsum("bhqd,bhkd->bhqk", q, k) * (Dh ** -0.5)
        p = _softmax(scores, axis=-1)
        o = torch.einsum("bhqk,bhkd->bhqd", p, v)
        return (lambda x, *d: x.permute(*d))(o, 0, 2, 1, 3).reshape(B, Sq, Hq * Dh) @ wo

    def _B_ref(x, w1, w2):
        h = torch.einsum("bsd,df->bsf", x, w1)
        h = _silu(h)
        out = torch.einsum("bsf,fd->bsd", h, w2)
        return out

    x = A_x
    x = x + _A_ref(_layernorm(x, axis=-1), A_k_cache, A_v_cache, A_wq, A_wo)
    x = x + _B_ref(_layernorm(x, axis=-1), B_w1, B_w2)
    x = x + _A_ref(_layernorm(x, axis=-1), A_k_cache, A_v_cache, A_wq, A_wo)
    x = x + _B_ref(_layernorm(x, axis=-1), B_w1, B_w2)
    return x
```

```asm
; @launch grid=(256,1,1) block=(256,1,1) lds=160768
.amdgcn_target "amdgcn-amd-amdhsa--gfx950"
.text
.globl interleave_layers__gqa_block_cached__dense_activation_silu__decode_kernel
.p2align 8
.type interleave_layers__gqa_block_cached__dense_activation_silu__decode_kernel,@function
interleave_layers__gqa_block_cached__dense_activation_silu__decode_kernel:
s_cmp_ge_u32 s2, 256
s_cbranch_scc1 L_end
s_load_dwordx16 s[4:19], s[0:1], 0
s_load_dwordx2 s[20:21], s[0:1], 64
s_load_dwordx2 s[24:25], s[0:1], 80
v_lshrrev_b32 v30, 6, v0
v_and_b32 v0, 63, v0
s_and_b32 s56, s2, 7
v_readfirstlane_b32 s59, v30
s_lshr_b32 s99, s2, 3
s_lshr_b32 s57, s99, 4
s_and_b32 s58, s99, 15
s_and_b32 s3, s58, 6
s_cmp_eq_u32 s3, 6
s_cselect_b32 s3, 8, 0
s_xor_b32 s98, s58, s3
v_and_b32 v31, 15, v0
v_lshrrev_b32_e64 v32, 4, v0
s_mul_i32 s26, s99, 0
s_mul_i32 s3, s59, 13
s_add_u32 s26, s26, s3
s_mul_i32 s3, s56, 20
s_add_u32 s26, s26, s3
s_and_b32 s26, s26, 31
s_lshl_b32 s27, s57, 3
s_add_u32 s27, s27, s56
s_lshl_b32 s79, s27, 21
s_lshl_b32 s3, s58, 17
s_add_u32 s79, s79, s3
s_lshl_b32 s3, s59, 15
s_add_u32 s79, s79, s3
s_add_u32 s80, s3, 16384
s_lshl_b32 s3, s26, 10
s_add_u32 s79, s79, s3
v_lshlrev_b32 v26, 4, v0
v_mov_b32 v96, v26
v_xor_b32_e64 v97, 64, v26
v_xor_b32 v98, 128, v26
v_xor_b32 v99, 192, v26
v_lshrrev_b32 v35, 3, v0
v_and_b32 v36, 7, v0
v_lshlrev_b32_e64 v36, 4, v36
v_lshl_add_u32 v104, v35, 13, v36
s_and_b32 s27, s99, 3
s_lshl_b32 s62, s27, 20
s_lshl_b32 s3, s59, 18
s_add_u32 s62, s62, s3
s_lshl_b32 s3, s56, 10
s_add_u32 s62, s62, s3
s_lshr_b32 s26, s99, 2
s_lshl_b32 s3, s26, 7
s_add_u32 s62, s62, s3
s_lshl_b32 s61, s59, 12
s_mov_b32 s101, s27
s_lshl_b32 s65, s56, 13
s_lshl_b32 s3, s26, 8
s_add_u32 s65, s65, s3
s_lshl_b32 s3, s27, 11
s_add_u32 s65, s65, s3
v_and_b32 v33, 1, v32
v_lshlrev_b32 v33, 3, v33
v_lshl_add_u32 v33, v31, 4, v33
s_lshl_b32 s3, s57, 10
s_lshl_b32 s26, s59, 8
s_add_u32 s3, s3, s26
v_add_u32 v34, s3, v33
v_lshrrev_b32 v35, 5, v0
v_lshlrev_b32 v35, 10, v35
v_xor_b32_e64 v34, v34, v35
v_mov_b32 v37, 917504
s_lshl_b32 s99, s99, 2
s_add_u32 s99, s99, s59
s_waitcnt lgkmcnt(0)
s_mov_b32 s28, s6
s_and_b32 s29, s7, 0xffff
s_mov_b32 s30, 0x2000000
s_mov_b32 s31, 0x20000
s_mov_b32 s36, s10
s_and_b32 s37, s11, 0xffff
s_mov_b32 s38, 0x400000
s_mov_b32 s39, 0x20000
s_mov_b32 s52, s24
s_and_b32 s53, s25, 0xffff
s_mov_b32 s54, 0xf1000
s_mov_b32 s55, 0x20000
global_load_dwordx2 v[106:107], v37, s[24:25] sc1
s_cmp_lg_u32 s59, 3
s_cbranch_scc1 L_sk1
s_mov_b32 s63, 0x05040100
s_mov_b32 s64, 0x07060302
s_lshl_b32 s27, s56, 1
s_add_u32 s27, s27, s57
s_lshl_b32 s66, s57, 3
s_add_u32 s66, s66, s56
s_lshl_b32 s66, s66, 13
s_lshl_b32 s3, s59, 9
s_add_u32 s66, s66, s3
s_add_u32 s66, s66, 327680
s_lshl_b32 s68, s27, 9
s_add_u32 s70, s68, 24576
s_add_u32 s68, s68, 16384
s_lshl_b32 s3, s58, 5
s_add_u32 s14, s68, s3
s_lshl_b32 s3, s98, 5
s_add_u32 s69, s70, s3
s_lshl_b32 s3, s58, 3
s_add_u32 s67, s68, s3
s_lshl_b32 s3, s59, 7
s_add_u32 s68, s68, s3
s_lshl_b32 s76, s27, 14
s_add_u32 s76, s76, 65536
s_lshl_b32 s3, s58, 10
s_add_u32 s81, s76, s3
s_lshl_b32 s3, s58, 4
s_add_u32 s75, s76, s3
s_lshl_b32 s3, s59, 10
s_add_u32 s75, s75, s3
s_lshl_b32 s3, s59, 12
s_add_u32 s76, s76, s3
s_lshl_b32 s72, s57, 13
s_add_u32 s72, s72, 32768
s_add_u32 s77, s72, 4096
s_add_u32 s74, s72, 16384
s_add_u32 s78, s74, 4096
s_lshl_b32 s3, s56, 10
s_add_u32 s71, s72, s3
s_lshl_b32 s3, s58, 6
s_add_u32 s71, s71, s3
s_add_u32 s73, s71, 16384
v_mul_u32_u24 v47, 458752, v32
v_mov_b32 v45, s71
v_mov_b32 v46, s14
v_subrev_u32 v46, 64, v46
v_cmp_le_u32 vcc, 4, v31
s_nop 1
v_cndmask_b32 v45, v45, v46, vcc
v_mov_b32_e64 v46, s69
v_subrev_u32 v46, 96, v46
v_cmp_le_u32 vcc, 6, v31
s_nop 1
v_cndmask_b32 v45, v45, v46, vcc
v_mov_b32 v46, s71
v_subrev_u32 v46, 128, v46
v_cmp_le_u32 vcc, 8, v31
s_nop 1
v_cndmask_b32 v45, v45, v46, vcc
v_mov_b32 v46, s73
v_subrev_u32 v46, 192, v46
v_cmp_le_u32 vcc, 12, v31
s_nop 1
v_cndmask_b32_e64 v45, v45, v46, vcc
v_lshl_add_u32 v45, v31, 4, v45
v_add_u32_e64 v45, v45, v47
s_add_u32 s3, s65, 921600
v_lshlrev_b32 v46, 4, v31
v_add_u32 v47, s3, v46
v_cmp_le_u32 vcc, 32, v0
s_nop 1
v_cndmask_b32 v45, v45, v47, vcc
v_and_b32 v47, 1, v32
v_lshl_add_u32 v46, v47, 16, v46
v_lshrrev_b32_e64 v47, 1, v32
v_mul_u32_u24 v47, 458752, v47
v_add_u32_e64 v46, v46, v47
s_add_u32 s14, s65, 327680
v_mov_b32 v48, -1
v_mov_b32 v49, -1
v_mov_b32 v50, -1
v_mov_b32 v51, -1
s_add_u32 s3, s81, 458752
s_mov_b32 exec_lo, 0xffffffff
s_mov_b32 exec_hi, 0xffff
buffer_store_dwordx4 v[48:51], v45, s[52:55], 0 offen sc1
s_mov_b64 exec, -1
buffer_store_dwordx4 v[48:51], v46, s[52:55], s14 offen sc1
buffer_store_dwordx4 v[48:51], v26, s[52:55], s81 offen sc1
buffer_store_dwordx4 v[48:51], v26, s[52:55], s3 offen sc1
L_sk1:
s_add_u32 m0, s61, 0
s_add_u32 s3, s62, 0
buffer_load_dwordx4 v104, s[36:39], s3 offen nt lds
s_add_u32 m0, s61, 1024
s_add_u32 s3, s62, 65536
buffer_load_dwordx4 v104, s[36:39], s3 offen nt lds
s_add_u32 m0, s61, 2048
s_add_u32 s3, s62, 131072
buffer_load_dwordx4 v104, s[36:39], s3 offen nt lds
s_add_u32 m0, s61, 3072
s_add_u32 s3, s62, 196608
buffer_load_dwordx4 v104, s[36:39], s3 offen nt lds
global_load_dwordx2 v[108:109], v34, s[4:5]
s_add_u32 m0, s80, 0
s_xor_b32 s26, s79, 0
buffer_load_dwordx4 v96, s[28:31], s26 offen nt lds
s_add_u32 m0, s80, 1024
s_xor_b32 s26, s79, 1024
buffer_load_dwordx4 v97, s[28:31], s26 offen nt lds
s_add_u32 m0, s80, 2048
s_xor_b32 s26, s79, 2048
buffer_load_dwordx4 v98, s[28:31], s26 offen nt lds
s_add_u32 m0, s80, 3072
s_xor_b32 s26, s79, 3072
buffer_load_dwordx4 v99, s[28:31], s26 offen nt lds
s_add_u32 m0, s80, 4096
s_xor_b32 s26, s79, 4096
buffer_load_dwordx4 v96, s[28:31], s26 offen nt lds
s_add_u32 m0, s80, 5120
s_xor_b32 s26, s79, 5120
buffer_load_dwordx4 v97, s[28:31], s26 offen nt lds
s_mov_b32 s32, s8
s_and_b32 s33, s9, 0xffff
s_mov_b32 s34, 0x2000000
s_mov_b32 s35, 0x20000
s_mov_b32 s40, s12
s_and_b32 s41, s13, 0xffff
s_mov_b32 s42, 0x400000
s_mov_b32 s43, 0x20000
s_mov_b32 s44, s16
s_and_b32 s45, s17, 0xffff
s_mov_b32 s46, 0x1c0000
s_mov_b32 s47, 0x20000
s_mov_b32 s48, s18
s_and_b32 s49, s19, 0xffff
s_mov_b32 s50, 0x1c0000
s_mov_b32 s51, 0x20000
s_cmp_eq_u32 s59, 3
s_cbranch_scc1 L_sk2
s_mov_b32 s63, 0x05040100
s_mov_b32 s64, 0x07060302
s_lshl_b32 s27, s56, 1
s_add_u32 s27, s27, s57
s_lshl_b32 s66, s57, 3
s_add_u32 s66, s66, s56
s_lshl_b32 s66, s66, 13
s_lshl_b32 s3, s59, 9
s_add_u32 s66, s66, s3
s_add_u32 s66, s66, 327680
s_lshl_b32 s68, s27, 9
s_add_u32 s70, s68, 24576
s_add_u32 s68, s68, 16384
s_lshl_b32 s3, s58, 5
s_add_u32 s14, s68, s3
s_lshl_b32 s3, s98, 5
s_add_u32 s69, s70, s3
s_lshl_b32 s3, s58, 3
s_add_u32 s67, s68, s3
s_lshl_b32 s3, s59, 7
s_add_u32 s68, s68, s3
s_lshl_b32 s76, s27, 14
s_add_u32 s76, s76, 65536
s_lshl_b32 s3, s58, 10
s_add_u32 s81, s76, s3
s_lshl_b32 s3, s58, 4
s_add_u32 s75, s76, s3
s_lshl_b32 s3, s59, 10
s_add_u32 s75, s75, s3
s_lshl_b32 s3, s59, 12
s_add_u32 s76, s76, s3
s_lshl_b32 s72, s57, 13
s_add_u32 s72, s72, 32768
s_add_u32 s77, s72, 4096
s_add_u32 s74, s72, 16384
s_add_u32 s78, s74, 4096
s_lshl_b32 s3, s56, 10
s_add_u32 s71, s72, s3
s_lshl_b32 s3, s58, 6
s_add_u32 s71, s71, s3
s_add_u32 s73, s71, 16384
L_sk2:
s_mov_b32 s61, 0
s_mov_b32 s62, 400000
s_mov_b32 exec_lo, 0x1
s_mov_b32 exec_hi, 0x0
v_mov_b32 v44, 0
buffer_load_dword a255, v44, s[32:35], s79 offen nt
s_mov_b64 exec, -1
s_lshl_b32 s3, s59, 9
s_add_u32 s3, s3, 147456
v_add_u32 v1, s3, v33
v_lshrrev_b32 v44, 3, v31
v_lshlrev_b32_e64 v44, 8, v44
v_lshl_add_u32 v44, v32, 4, v44
v_add_u32 v2, s3, v44
v_lshlrev_b32 v47, 2, v0
v_add_u32_e64 v44, s3, v47
v_mov_b32 v41, 0x3f803f80
ds_write_b32 v44, v41 offset:256
s_lshl_b32 s3, s59, 2
s_add_u32 s27, s3, 150528
v_add_u32 v3, s27, v26
v_lshrrev_b32_e64 v46, 5, v0
v_lshl_add_u32 v46, v46, 4, v31
v_lshlrev_b32_e64 v46, 4, v46
s_add_u32 s27, s3, 151552
v_add_u32_e64 v4, s27, v46
s_add_u32 s27, s3, 152064
v_mov_b32 v24, s27
v_and_b32 v42, 3, v0
v_lshlrev_b32_e64 v43, 4, v42
v_add_u32 v22, 152192, v43
v_add_u32 v22, s3, v22
s_lshl_b32 s3, s59, 8
v_lshlrev_b32_e64 v43, 4, v32
v_add_u32 v23, 152192, v43
v_and_b32 v44, 1, v32
v_lshlrev_b32 v44, 16, v44
v_lshl_add_u32 v5, v31, 2, v44
v_lshrrev_b32 v44, 5, v0
v_xor_b32 v44, s57, v44
v_lshlrev_b32_e64 v44, 8, v44
v_add_u32 v44, 149504, v44
v_add_u32_e64 v27, v44, v33
v_bfe_u32 v44, v0, 2, 1
v_lshlrev_b32_e64 v44, 8, v44
v_add3_u32 v44, v44, v43, 0
v_add_u32 v44, 149504, v44
v_accvgpr_write_b32 a238, v44
v_lshrrev_b32 v44, 2, v0
v_lshlrev_b32 v44, 6, v44
v_lshl_add_u32 v44, v42, 2, v44
s_lshl_b32 s27, s59, 4
s_add_u32 s27, s27, 152576
v_add_u32 v44, s27, v44
v_accvgpr_write_b32 a239, v44
v_lshlrev_b32_e64 v44, 4, v31
v_lshl_add_u32 v44, v32, 10, v44
v_add_u32 v7, s3, v44
v_mov_b32 v8, v43
v_lshlrev_b32_e64 v44, 4, v42
v_lshl_add_u32 v9, v32, 6, v44
v_add_u32 v9, 152576, v9
v_lshl_add_u32 v44, v32, 2, v42
v_lshlrev_b32 v6, 3, v44
v_lshlrev_b32_e64 v10, 1, v0
s_lshl_b32 s3, s59, 11
s_add_u32 s3, s3, 152576
v_lshlrev_b32 v44, 4, v31
v_add_u32_e64 v11, s3, v26
s_lshl_b32 s3, s59, 9
s_add_u32 s3, s3, 152576
v_lshl_add_u32 v44, v32, 2, v44
v_add_u32 v20, s3, v44
v_lshrrev_b32 v45, 2, v31
v_lshlrev_b32_e64 v44, 8, v45
v_lshl_add_u32 v44, v42, 2, v44
v_lshl_add_u32 v21, v32, 12, v44
s_and_b32 s3, s59, 1
s_lshl_b32 s3, s3, 5
v_lshlrev_b32 v44, 3, v32
v_add_u32 v25, s3, v44
v_mul_u32_u24 v44, 1088, v42
v_lshl_add_u32 v44, v45, 8, v44
v_add_u32 v44, v44, v43
v_xor_b32 v46, 0, v44
v_add_u32 v100, s80, v46
v_xor_b32 v46, 64, v44
v_add_u32_e64 v101, s80, v46
v_xor_b32 v46, 128, v44
v_add_u32_e64 v102, s80, v46
v_xor_b32 v46, 192, v44
v_add_u32 v103, s80, v46
v_and_b32 v44, 1, v31
v_lshlrev_b32_e64 v44, 4, v44
v_mov_b32 v46, 0x3f80
v_lshlrev_b32 v46, v44, v46
v_lshrrev_b32 v44, 1, v31
v_cmp_eq_u32 vcc, 0, v44
s_nop 1
v_cndmask_b32 v12, 0, v46, vcc
v_cmp_eq_u32 vcc, 1, v44
s_nop 1
v_cndmask_b32 v13, 0, v46, vcc
v_cmp_eq_u32 vcc, 2, v44
s_nop 1
v_cndmask_b32 v14, 0, v46, vcc
v_cmp_eq_u32 vcc, 3, v44
s_nop 1
v_cndmask_b32 v15, 0, v46, vcc
v_lshl_add_u32 v46, v32, 3, v45
v_lshlrev_b32_e64 v46, 7, v46
v_lshl_add_u32 v46, v42, 3, v46
s_lshl_b32 s3, s59, 5
v_add_u32 v105, s3, v46
s_add_u32 m0, s80, 6144
s_xor_b32 s26, s79, 6144
buffer_load_dwordx4 v98, s[28:31], s26 offen nt lds
s_add_u32 m0, s80, 7168
s_xor_b32 s26, s79, 7168
buffer_load_dwordx4 v99, s[28:31], s26 offen nt lds
s_waitcnt vmcnt(9)
v_readfirstlane_b32 s22, v106
v_readfirstlane_b32 s23, v107
s_add_u32 s22, s22, 1
s_andn2_b32 s23, s23, 15
s_cmp_eq_u32 s59, s101
s_cselect_b32 s3, 64, 32
v_cmp_gt_u32 vcc, s3, v0
s_nop 1
v_cndmask_b32 v28, 0, v108, vcc
v_cndmask_b32_e64 v29, 0, v109, vcc
s_xor_b32 s4, s72, 8192
s_xor_b32 s5, s74, 8192
s_cmp_lg_u32 s59, s101
s_cbranch_scc1 L_sk3
ds_write_b64 v27, v[28:29]
L_sk3:
v_accvgpr_read_b32 v57, a238
v_lshlrev_b32_e64 v16, 16, v28
v_and_b32 v17, 0xffff0000, v28
v_lshlrev_b32_e64 v18, 16, v29
v_and_b32 v19, 0xffff0000, v29
v_add_f32 v30, v16, v17
v_mul_f32 v31, v16, v16
v_add_f32 v56, v18, v19
v_fmac_f32 v31, v17, v17
v_add_f32 v30, v30, v56
v_fmac_f32 v31, v18, v18
v_fmac_f32_e64 v31, v19, v19
v_add_f32_dpp v30, v30, v30 row_ror:8 row_mask:0xf bank_mask:0xf
s_nop 0
v_add_f32_dpp v31, v31, v31 row_ror:8 row_mask:0xf bank_mask:0xf
v_add_f32_dpp v30, v30, v30 row_ror:4 row_mask:0xf bank_mask:0xf
s_nop 0
v_add_f32_dpp v31, v31, v31 row_ror:4 row_mask:0xf bank_mask:0xf
v_add_f32_dpp v30, v30, v30 row_ror:2 row_mask:0xf bank_mask:0xf
s_nop 0
v_add_f32_dpp v31, v31, v31 row_ror:2 row_mask:0xf bank_mask:0xf
v_add_f32_dpp v30, v30, v30 row_ror:1 row_mask:0xf bank_mask:0xf
s_nop 0
v_add_f32_dpp v31, v31, v31 row_ror:1 row_mask:0xf bank_mask:0xf
v_add_f32_dpp v30, v30, v30 row_bcast:15 row_mask:0xa bank_mask:0xf
s_nop 0
v_add_f32_dpp v31, v31, v31 row_bcast:15 row_mask:0xa bank_mask:0xf
s_mov_b32 exec_lo, 0x10000
s_mov_b32 exec_hi, 0x0
ds_write2_b32 v24, v30, v31 offset0:0 offset1:4
s_mov_b64 exec, -1
s_waitcnt lgkmcnt(0)
s_barrier
ds_read_b64_tr_b16 a[128:129], v105 offset:0
ds_read_b64_tr_b16 a[130:131], v105 offset:512
ds_read_b64_tr_b16 a[132:133], v105 offset:4096
ds_read_b64_tr_b16 a[134:135], v105 offset:4608
ds_read_b64_tr_b16 a[136:137], v105 offset:8192
ds_read_b64_tr_b16 a[138:139], v105 offset:8704
ds_read_b64_tr_b16 a[140:141], v105 offset:12288
ds_read_b64_tr_b16 a[142:143], v105 offset:12800
s_add_u32 m0, s80, 8192
s_xor_b32 s26, s79, 8192
buffer_load_dwordx4 v96, s[28:31], s26 offen nt lds
s_add_u32 m0, s80, 9216
s_xor_b32 s26, s79, 9216
buffer_load_dwordx4 v97, s[28:31], s26 offen nt lds
ds_read_b128 v[32:35], v57 offset:0
ds_read_b128 v[36:39], v57 offset:64
ds_read_b128 v[40:43], v57 offset:128
ds_read_b128 v[44:47], v57 offset:192
v_mov_b32 v58, 152064
ds_read_b128 v[52:55], v58
ds_read_b128 v[56:59], v58 offset:16
s_lshl_b32 s3, s59, 6
s_add_u32 s3, s3, s65
s_add_u32 s14, s3, 921600
s_add_u32 s3, s3, 327680
s_waitcnt lgkmcnt(0)
v_mfma_f32_16x16x32_bf16 v[48:51], v[32:35], a[128:131], 0
s_waitcnt lgkmcnt(0)
v_mfma_f32_16x16x32_bf16 v[48:51], v[36:39], a[132:135], v[48:51]
s_waitcnt lgkmcnt(0)
v_mfma_f32_16x16x32_bf16 v[48:51], v[40:43], a[136:139], v[48:51]
s_waitcnt lgkmcnt(0)
v_mfma_f32_16x16x32_bf16 v[48:51], v[44:47], a[140:143], v[48:51]
s_waitcnt lgkmcnt(0)
v_add_f32 v52, v52, v53
v_add_f32 v54, v54, v55
v_add_f32 v56, v56, v57
v_add_f32 v58, v58, v59
v_add_f32 v52, v52, v54
v_add_f32 v56, v56, v58
s_add_u32 m0, s80, 10240
s_xor_b32 s26, s79, 10240
buffer_load_dwordx4 v98, s[28:31], s26 offen nt lds
s_add_u32 m0, s80, 11264
s_xor_b32 s26, s79, 11264
buffer_load_dwordx4 v99, s[28:31], s26 offen nt lds
v_mul_f32 v62, 0x3b000000, v52
v_mul_f32 v56, 0x3b000000, v56
v_fma_f32 v56, -v62, v62, v56
v_max_f32_e64 v56, 0, v56
v_add_f32 v56, 0x3727c5ac, v56
v_rsq_f32 v56, v56
s_nop 0
v_mul_f32 v63, 0x3e0293ee, v56
v_mov_b32 v32, 0x3f803f80
v_mov_b32 v33, 0x3f803f80
v_mov_b32 v34, 0x3f803f80
v_mov_b32 v35, 0x3f803f80
s_nop 0
s_nop 0
v_mfma_f32_16x16x32_bf16 v[52:55], v[32:35], a[128:131], 0
v_mfma_f32_16x16x32_bf16 v[52:55], v[32:35], a[132:135], v[52:55]
v_mfma_f32_16x16x32_bf16 v[52:55], v[32:35], a[136:139], v[52:55]
v_mfma_f32_16x16x32_bf16 v[52:55], v[32:35], a[140:143], v[52:55]
s_add_u32 m0, s80, 12288
s_xor_b32 s26, s79, 12288
buffer_load_dwordx4 v96, s[28:31], s26 offen nt lds
s_cmp_lg_u32 s59, 3
s_cbranch_scc1 L_sk4
s_waitcnt vmcnt(19)
v_readfirstlane_b32 s22, v106
v_readfirstlane_b32 s23, v107
s_add_u32 s22, s22, 1
s_andn2_b32 s23, s23, 15
s_getreg_b32 s3, hwreg(HW_REG_XCC_ID, 0, 4)
s_or_b32 s3, s3, s23
v_mov_b32 v46, s22
v_mov_b32 v47, s3
s_lshl_b32 s3, s57, 3
s_add_u32 s3, s3, s56
s_lshl_b32 s3, s3, 4
s_add_u32 s3, s3, s58
s_lshl_b32 s3, s3, 3
s_add_u32 s3, s3, 918528
v_mov_b32_e64 v45, 0
s_mov_b32 exec_lo, 0x1
s_mov_b32 exec_hi, 0x0
buffer_store_dwordx2 v[46:47], v45, s[52:55], s3 offen sc1
s_mov_b64 exec, -1
L_sk4:
s_add_u32 m0, s80, 13312
s_xor_b32 s26, s79, 13312
buffer_load_dwordx4 v97, s[28:31], s26 offen nt lds
s_add_u32 m0, s80, 14336
s_xor_b32 s26, s79, 14336
buffer_load_dwordx4 v98, s[28:31], s26 offen nt lds
s_add_u32 m0, s80, 15360
s_xor_b32 s26, s79, 15360
buffer_load_dwordx4 v99, s[28:31], s26 offen nt lds
s_add_u32 m0, s80, 16384
s_xor_b32 s26, s79, 16384
buffer_load_dwordx4 v96, s[28:31], s26 offen nt lds
s_barrier
s_lshl_b32 s3, s59, 6
s_add_u32 s3, s3, s65
s_add_u32 s14, s3, 921600
s_add_u32 s3, s3, 327680
s_mov_b32 exec_lo, 0xffffffff
s_mov_b32 exec_hi, 0x0
buffer_store_dword v48, v5, s[52:55], s3 offen sc1
s_mov_b32 exec_lo, 0xffff
s_mov_b32 exec_hi, 0x0
buffer_store_dword v52, v5, s[52:55], s14 offen sc1
s_mov_b64 exec, -1
s_add_u32 m0, s80, 17408
s_xor_b32 s26, s79, 17408
buffer_load_dwordx4 v97, s[28:31], s26 offen nt lds
s_add_u32 m0, s80, 18432
s_xor_b32 s26, s79, 18432
buffer_load_dwordx4 v98, s[28:31], s26 offen nt lds
s_add_u32 m0, s80, 19456
s_xor_b32 s26, s79, 19456
buffer_load_dwordx4 v99, s[28:31], s26 offen nt lds
s_waitcnt vmcnt(19)
ds_read_b128 a[0:3], v100 offset:0
ds_read_b128 a[4:7], v101 offset:0
ds_read_b128 a[8:11], v102 offset:0
ds_read_b128 a[12:15], v103 offset:0
s_add_u32 m0, s80, 20480
s_xor_b32 s26, s79, 20480
buffer_load_dwordx4 v96, s[28:31], s26 offen nt lds
s_add_u32 m0, s80, 21504
s_xor_b32 s26, s79, 21504
buffer_load_dwordx4 v97, s[28:31], s26 offen nt lds
s_add_u32 m0, s80, 22528
s_xor_b32 s26, s79, 22528
buffer_load_dwordx4 v98, s[28:31], s26 offen nt lds
s_add_u32 m0, s80, 23552
s_xor_b32 s26, s79, 23552
buffer_load_dwordx4 v99, s[28:31], s26 offen nt lds
s_waitcnt vmcnt(18)
ds_read_b128 a[16:19], v100 offset:4096
ds_read_b128 a[20:23], v101 offset:4096
ds_read_b128 a[24:27], v102 offset:4096
ds_read_b128 a[28:31], v103 offset:4096
s_add_u32 m0, s80, 24576
s_xor_b32 s26, s79, 24576
buffer_load_dwordx4 v96, s[28:31], s26 offen nt lds
s_add_u32 m0, s80, 25600
s_xor_b32 s26, s79, 25600
buffer_load_dwordx4 v97, s[28:31], s26 offen nt lds
s_add_u32 m0, s80, 26624
s_xor_b32 s26, s79, 26624
buffer_load_dwordx4 v98, s[28:31], s26 offen nt lds
s_add_u32 m0, s80, 27648
s_xor_b32 s26, s79, 27648
buffer_load_dwordx4 v99, s[28:31], s26 offen nt lds
s_waitcnt vmcnt(18)
ds_read_b128 a[32:35], v100 offset:8192
ds_read_b128 a[36:39], v101 offset:8192
ds_read_b128 a[40:43], v102 offset:8192
ds_read_b128 a[44:47], v103 offset:8192
s_add_u32 m0, s80, 28672
s_xor_b32 s26, s79, 28672
buffer_load_dwordx4 v96, s[28:31], s26 offen nt lds
s_add_u32 m0, s80, 29696
s_xor_b32 s26, s79, 29696
buffer_load_dwordx4 v97, s[28:31], s26 offen nt lds
s_add_u32 m0, s80, 30720
s_xor_b32 s26, s79, 30720
buffer_load_dwordx4 v98, s[28:31], s26 offen nt lds
s_mov_b32 s3, 918528
buffer_load_dwordx4 v[32:35], v26, s[52:55], s3 offen sc1
buffer_load_dwordx4 v[36:39], v26, s[52:55], s3 offen offset:1024 sc1
s_add_u32 m0, s80, 31744
s_xor_b32 s26, s79, 31744
buffer_load_dwordx4 v99, s[28:31], s26 offen nt lds
s_waitcnt vmcnt(20)
ds_read_b128 a[48:51], v100 offset:12288
ds_read_b128 a[52:55], v101 offset:12288
ds_read_b128 a[56:59], v102 offset:12288
ds_read_b128 a[60:63], v103 offset:12288
s_xor_b32 s27, s79, 0
buffer_load_dwordx4 v[128:131], v26, s[32:35], s27 offen nt
s_xor_b32 s27, s79, 1024
buffer_load_dwordx4 v[132:135], v26, s[32:35], s27 offen nt
s_xor_b32 s27, s79, 2048
buffer_load_dwordx4 v[136:139], v26, s[32:35], s27 offen nt
s_xor_b32 s27, s79, 3072
buffer_load_dwordx4 v[140:143], v26, s[32:35], s27 offen nt
s_waitcnt vmcnt(18)
ds_read_b128 a[64:67], v100 offset:16384
ds_read_b128 a[68:71], v101 offset:16384
ds_read_b128 a[72:75], v102 offset:16384
ds_read_b128 a[76:79], v103 offset:16384
s_xor_b32 s27, s79, 4096
buffer_load_dwordx4 v[144:147], v26, s[32:35], s27 offen nt
s_xor_b32 s27, s79, 5120
buffer_load_dwordx4 v[148:151], v26, s[32:35], s27 offen nt
s_xor_b32 s27, s79, 6144
buffer_load_dwordx4 v[152:155], v26, s[32:35], s27 offen nt
s_xor_b32 s27, s79, 7168
buffer_load_dwordx4 v[156:159], v26, s[32:35], s27 offen nt
s_waitcnt vmcnt(18)
ds_read_b128 a[80:83], v100 offset:20480
ds_read_b128 a[84:87], v101 offset:20480
ds_read_b128 a[88:91], v102 offset:20480
ds_read_b128 a[92:95], v103 offset:20480
s_xor_b32 s27, s79, 8192
buffer_load_dwordx4 v[160:163], v26, s[32:35], s27 offen nt
s_waitcnt vmcnt(10)
L_cen5:
v_xor_b32 v32, s22, v32
v_xor_b32 v33, s23, v33
v_xor_b32 v34, s22, v34
v_xor_b32 v35, s23, v35
v_xor_b32 v36, s22, v36
v_xor_b32 v37, s23, v37
v_xor_b32 v38, s22, v38
v_xor_b32 v39, s23, v39
v_or3_b32 v40, v33, v35, v37
v_or3_b32 v42, v32, v34, v36
v_or_b32 v40, v40, v39
v_and_b32 v40, -16, v40
v_or3_b32 v40, v40, v42, v38
v_cmp_ne_u32 vcc, 0, v40
s_or_b32 s11, vcc_lo, vcc_hi
s_lshl_b32 s3, s56, 3
s_lshr_b64 s[14:15], vcc, s3
s_and_b32 s14, s14, 0xff
s_cbranch_scc0 L_cok6
s_sleep 4
s_mov_b32 s3, 918528
buffer_load_dwordx4 v[32:35], v26, s[52:55], s3 offen sc1
buffer_load_dwordx4 v[36:39], v26, s[52:55], s3 offen offset:1024 sc1
s_waitcnt vmcnt(0)
s_sub_u32 s62, s62, 1
s_cbranch_scc0 L_cen5
s_mov_b32 s62, 0
L_cok6:
s_getreg_b32 s3, hwreg(HW_REG_XCC_ID, 0, 4)
v_xor_b32 v33, s3, v33
v_xor_b32 v35, s3, v35
v_xor_b32 v37, s3, v37
v_xor_b32 v39, s3, v39
v_or_b32 v33, v33, v35
v_or3_b32 v33, v33, v37, v39
v_cmp_eq_u32_e64 vcc, 0, v33
s_lshl_b32 s3, s56, 3
s_lshr_b64 s[14:15], vcc, s3
s_and_b32 s14, s14, 0xff
s_cmp_eq_u32 s14, 0xff
s_cselect_b32 s60, 1, 0
s_lshl_b32 s15, s56, 13
s_lshl_b32 s3, s59, 9
s_add_u32 s15, s15, s3
s_add_u32 s15, s15, 921600
v_lshlrev_b32_e64 v60, 3, v0
v_add_u32 v61, 4096, v60
s_xor_b32 s27, s79, 9216
buffer_load_dwordx4 v[164:167], v26, s[32:35], s27 offen nt
s_xor_b32 s27, s79, 10240
buffer_load_dwordx4 v[168:171], v26, s[32:35], s27 offen nt
buffer_load_dwordx2 v[44:45], v60, s[52:55], s66 offen offset:0 sc1
buffer_load_dwordx2 v[46:47], v60, s[52:55], s66 offen offset:2048 sc1
buffer_load_dwordx2 v[48:49], v61, s[52:55], s66 offen offset:0 sc1
buffer_load_dwordx2 v[50:51], v61, s[52:55], s66 offen offset:2048 sc1
buffer_load_dwordx2 v[32:33], v60, s[52:55], s15 offen offset:0 sc1
buffer_load_dwordx2 v[34:35], v60, s[52:55], s15 offen offset:2048 sc1
buffer_load_dwordx2 v[36:37], v61, s[52:55], s15 offen offset:0 sc1
buffer_load_dwordx2 v[38:39], v61, s[52:55], s15 offen offset:2048 sc1
s_xor_b32 s27, s79, 11264
buffer_load_dwordx4 v[172:175], v26, s[32:35], s27 offen nt
s_waitcnt vmcnt(26)
ds_read_b128 a[96:99], v100 offset:24576
ds_read_b128 a[100:103], v101 offset:24576
ds_read_b128 a[104:107], v102 offset:24576
ds_read_b128 a[108:111], v103 offset:24576
s_xor_b32 s27, s79, 12288
buffer_load_dwordx4 v[176:179], v26, s[32:35], s27 offen nt
s_xor_b32 s27, s79, 13312
buffer_load_dwordx4 v[180:183], v26, s[32:35], s27 offen nt
s_xor_b32 s27, s79, 14336
buffer_load_dwordx4 v[184:187], v26, s[32:35], s27 offen nt
s_xor_b32 s27, s79, 15360
buffer_load_dwordx4 v[188:191], v26, s[32:35], s27 offen nt
s_waitcnt vmcnt(24)
ds_read_b128 a[112:115], v100 offset:28672
ds_read_b128 a[116:119], v101 offset:28672
ds_read_b128 a[120:123], v102 offset:28672
ds_read_b128 a[124:127], v103 offset:28672
s_xor_b32 s27, s79, 16384
buffer_load_dwordx4 v[192:195], v26, s[32:35], s27 offen nt
s_xor_b32 s27, s79, 17408
buffer_load_dwordx4 v[196:199], v26, s[32:35], s27 offen nt
s_xor_b32 s27, s79, 18432
buffer_load_dwordx4 v[200:203], v26, s[32:35], s27 offen nt
s_waitcnt vmcnt(8)
L_ql7:
v_add_f32 v44, v44, v46
v_add_f32 v45, v45, v47
v_add_f32 v48, v48, v50
v_add_f32 v49, v49, v51
v_add_f32 v44, v44, v48
v_add_f32 v45, v45, v49
v_add_f32 v32, v32, v34
v_add_f32 v33, v33, v35
v_add_f32 v36, v36, v38
v_add_f32 v37, v37, v39
v_add_f32 v32, v32, v36
v_add_f32 v33, v33, v37
v_add_f32 v40, v44, v45
v_add_f32 v41, v32, v33
v_cmp_u_f32_e64 vcc, v40, v41
s_cbranch_vccz L_qlok8
buffer_load_dwordx2 v[44:45], v60, s[52:55], s66 offen offset:0 sc1
buffer_load_dwordx2 v[46:47], v60, s[52:55], s66 offen offset:2048 sc1
buffer_load_dwordx2 v[48:49], v61, s[52:55], s66 offen offset:0 sc1
buffer_load_dwordx2 v[50:51], v61, s[52:55], s66 offen offset:2048 sc1
buffer_load_dwordx2 v[32:33], v60, s[52:55], s15 offen offset:0 sc1
buffer_load_dwordx2 v[34:35], v60, s[52:55], s15 offen offset:2048 sc1
buffer_load_dwordx2 v[36:37], v61, s[52:55], s15 offen offset:0 sc1
buffer_load_dwordx2 v[38:39], v61, s[52:55], s15 offen offset:2048 sc1
s_waitcnt vmcnt(0)
s_sub_u32 s62, s62, 1
s_cbranch_scc0 L_ql7
s_mov_b32 s62, 0
L_qlok8:
v_accvgpr_write_b32 a236, v32
v_accvgpr_write_b32 a237, v33
v_accvgpr_read_b32 v59, a239
v_mov_b32 v56, v32
v_mov_b32 v57, v33
v_fma_f32 v44, -v62, v56, v44
v_fma_f32 v45, -v62, v57, v45
v_mul_f32 v44, v44, v63
v_mul_f32 v45, v45, v63
v_cvt_pk_bf16_f32 v44, v44, v45
ds_write_b32 v59, v44
s_waitcnt lgkmcnt(0)
s_barrier
ds_read_b128 v[28:31], v9 offset:0
ds_read_b128 v[32:35], v9 offset:256
ds_read_b128 v[36:39], v9 offset:512
ds_read_b128 v[40:43], v9 offset:768
s_xor_b32 s27, s79, 19456
buffer_load_dwordx4 v[204:207], v26, s[32:35], s27 offen nt
s_waitcnt lgkmcnt(0)
v_mfma_f32_16x16x32_bf16 v[44:47], a[0:3], v[28:31], 0
v_mfma_f32_16x16x32_bf16 v[44:47], a[4:7], v[32:35], v[44:47]
v_mfma_f32_16x16x32_bf16 v[44:47], a[8:11], v[36:39], v[44:47]
v_mfma_f32_16x16x32_bf16 v[44:47], a[12:15], v[40:43], v[44:47]
s_xor_b32 s27, s79, 20480
buffer_load_dwordx4 v[208:211], v26, s[32:35], s27 offen nt
s_xor_b32 s27, s79, 21504
buffer_load_dwordx4 v[212:215], v26, s[32:35], s27 offen nt
v_mfma_f32_16x16x32_bf16 v[48:51], a[16:19], v[28:31], 0
v_mfma_f32_16x16x32_bf16 v[48:51], a[20:23], v[32:35], v[48:51]
v_mfma_f32_16x16x32_bf16 v[48:51], a[24:27], v[36:39], v[48:51]
v_mfma_f32_16x16x32_bf16 v[48:51], a[28:31], v[40:43], v[48:51]
s_xor_b32 s27, s79, 22528
buffer_load_dwordx4 v[216:219], v26, s[32:35], s27 offen nt
s_xor_b32 s27, s79, 23552
buffer_load_dwordx4 v[220:223], v26, s[32:35], s27 offen nt
v_mfma_f32_16x16x32_bf16 v[60:63], a[32:35], v[28:31], 0
v_mfma_f32_16x16x32_bf16 v[60:63], a[36:39], v[32:35], v[60:63]
v_mfma_f32_16x16x32_bf16 v[60:63], a[40:43], v[36:39], v[60:63]
v_mfma_f32_16x16x32_bf16 v[60:63], a[44:47], v[40:43], v[60:63]
s_xor_b32 s27, s79, 24576
buffer_load_dwordx4 v[224:227], v26, s[32:35], s27 offen nt
s_xor_b32 s27, s79, 25600
buffer_load_dwordx4 v[228:231], v26, s[32:35], s27 offen nt
v_mfma_f32_16x16x32_bf16 v[52:55], a[48:51], v[28:31], 0
v_mfma_f32_16x16x32_bf16 v[52:55], a[52:55], v[32:35], v[52:55]
v_mfma_f32_16x16x32_bf16 v[52:55], a[56:59], v[36:39], v[52:55]
v_mfma_f32_16x16x32_bf16 v[52:55], a[60:63], v[40:43], v[52:55]
s_xor_b32 s27, s79, 26624
buffer_load_dwordx4 v[232:235], v26, s[32:35], s27 offen nt
s_xor_b32 s27, s79, 27648
buffer_load_dwordx4 v[236:239], v26, s[32:35], s27 offen nt
v_mfma_f32_16x16x32_bf16 v[56:59], a[64:67], v[28:31], 0
v_mov_b32_dpp v44, v60 quad_perm:[0,1,2,3] row_mask:0xf bank_mask:0x2
v_mfma_f32_16x16x32_bf16 v[56:59], a[68:71], v[32:35], v[56:59]
v_mov_b32_dpp v45, v61 quad_perm:[0,1,2,3] row_mask:0xf bank_mask:0x2
v_mfma_f32_16x16x32_bf16 v[56:59], a[72:75], v[36:39], v[56:59]
v_mov_b32_dpp v46, v62 quad_perm:[0,1,2,3] row_mask:0xf bank_mask:0x2
v_mfma_f32_16x16x32_bf16 v[56:59], a[76:79], v[40:43], v[56:59]
v_mov_b32_dpp v47, v63 quad_perm:[0,1,2,3] row_mask:0xf bank_mask:0x2
s_xor_b32 s27, s79, 28672
buffer_load_dwordx4 v[240:243], v26, s[32:35], s27 offen nt
s_xor_b32 s27, s79, 29696
buffer_load_dwordx4 v[244:247], v26, s[32:35], s27 offen nt
v_mfma_f32_16x16x32_bf16 v[60:63], a[80:83], v[28:31], 0
v_mov_b32_dpp v48, v52 quad_perm:[0,1,2,3] row_mask:0xf bank_mask:0x2
v_mfma_f32_16x16x32_bf16 v[60:63], a[84:87], v[32:35], v[60:63]
v_mov_b32_dpp v49, v53 quad_perm:[0,1,2,3] row_mask:0xf bank_mask:0x2
v_mfma_f32_16x16x32_bf16 v[60:63], a[88:91], v[36:39], v[60:63]
v_mov_b32_dpp v50, v54 quad_perm:[0,1,2,3] row_mask:0xf bank_mask:0x2
v_mfma_f32_16x16x32_bf16 v[60:63], a[92:95], v[40:43], v[60:63]
v_mov_b32_dpp v51, v55 quad_perm:[0,1,2,3] row_mask:0xf bank_mask:0x2
s_xor_b32 s27, s79, 30720
buffer_load_dwordx4 v[248:251], v26, s[32:35], s27 offen nt
s_xor_b32 s27, s79, 31744
buffer_load_dwordx4 v[252:255], v26, s[32:35], s27 offen nt
v_mfma_f32_16x16x32_bf16 v[52:55], a[96:99], v[28:31], 0
v_mov_b32_dpp v44, v56 quad_perm:[0,1,2,3] row_mask:0xf bank_mask:0x4
v_mfma_f32_16x16x32_bf16 v[52:55], a[100:103], v[32:35], v[52:55]
v_mov_b32_dpp v45, v57 quad_perm:[0,1,2,3] row_mask:0xf bank_mask:0x4
v_mfma_f32_16x16x32_bf16 v[52:55], a[104:107], v[36:39], v[52:55]
v_mov_b32_dpp v46, v58 quad_perm:[0,1,2,3] row_mask:0xf bank_mask:0x4
v_mfma_f32_16x16x32_bf16 v[52:55], a[108:111], v[40:43], v[52:55]
v_mov_b32_dpp v47, v59 quad_perm:[0,1,2,3] row_mask:0xf bank_mask:0x4
v_mfma_f32_16x16x32_bf16 v[56:59], a[112:115], v[28:31], 0
v_mov_b32_dpp v48, v60 quad_perm:[0,1,2,3] row_mask:0xf bank_mask:0x4
v_mfma_f32_16x16x32_bf16 v[56:59], a[116:119], v[32:35], v[56:59]
v_mov_b32_dpp v49, v61 quad_perm:[0,1,2,3] row_mask:0xf bank_mask:0x4
v_mfma_f32_16x16x32_bf16 v[56:59], a[120:123], v[36:39], v[56:59]
v_mov_b32_dpp v50, v62 quad_perm:[0,1,2,3] row_mask:0xf bank_mask:0x4
v_mfma_f32_16x16x32_bf16 v[56:59], a[124:127], v[40:43], v[56:59]
v_mov_b32_dpp v51, v63 quad_perm:[0,1,2,3] row_mask:0xf bank_mask:0x4
v_mov_b32_dpp v44, v52 quad_perm:[0,1,2,3] row_mask:0xf bank_mask:0x8
v_mov_b32_dpp v45, v53 quad_perm:[0,1,2,3] row_mask:0xf bank_mask:0x8
v_mov_b32_dpp v46, v54 quad_perm:[0,1,2,3] row_mask:0xf bank_mask:0x8
v_mov_b32_dpp v47, v55 quad_perm:[0,1,2,3] row_mask:0xf bank_mask:0x8
s_nop 2
v_mov_b32_dpp v48, v56 quad_perm:[0,1,2,3] row_mask:0xf bank_mask:0x8
v_mov_b32_dpp v49, v57 quad_perm:[0,1,2,3] row_mask:0xf bank_mask:0x8
v_mov_b32_dpp v50, v58 quad_perm:[0,1,2,3] row_mask:0xf bank_mask:0x8
v_mov_b32_dpp v51, v59 quad_perm:[0,1,2,3] row_mask:0xf bank_mask:0x8
v_max3_f32 v32, v44, v45, v46
v_max3_f32 v33, v47, v48, v49
v_max3_f32 v32, v32, v50, v51
v_max_f32 v32, v32, v33
s_nop 1
v_max_f32_dpp v32, v32, v32 row_ror:4 row_mask:0xf bank_mask:0xf
s_nop 0
s_nop 0
v_max_f32_dpp v32, v32, v32 row_ror:8 row_mask:0xf bank_mask:0xf
v_mov_b32 v33, v32
s_nop 1
v_permlane16_swap_b32 v32, v33
v_max_f32 v32, v32, v33
v_mov_b32 v33, v32
s_nop 1
v_permlane32_swap_b32 v32, v33
v_max_f32 v32, v32, v33
v_sub_f32 v44, v44, v32
v_sub_f32 v45, v45, v32
v_sub_f32 v46, v46, v32
v_sub_f32 v47, v47, v32
v_sub_f32 v48, v48, v32
v_sub_f32 v49, v49, v32
v_sub_f32 v50, v50, v32
v_sub_f32 v51, v51, v32
ds_write_b32 v22, v32
v_exp_f32 v44, v44
v_exp_f32 v45, v45
v_exp_f32 v46, v46
v_exp_f32 v47, v47
v_exp_f32 v48, v48
v_exp_f32 v49, v49
v_exp_f32 v50, v50
v_exp_f32 v51, v51
v_cvt_pk_bf16_f32 v28, v44, v45
v_cvt_pk_bf16_f32 v29, v46, v47
v_cvt_pk_bf16_f32 v30, v48, v49
v_cvt_pk_bf16_f32 v31, v50, v51
v_mov_b32_dpp v52, v28 row_ror:12 row_mask:0xf bank_mask:0xf
v_mov_b32_dpp v53, v29 row_ror:12 row_mask:0xf bank_mask:0xf
v_mov_b32_dpp v54, v30 row_ror:12 row_mask:0xf bank_mask:0xf
v_mov_b32_dpp v55, v31 row_ror:12 row_mask:0xf bank_mask:0xf
v_mov_b32_dpp v56, v28 row_ror:8 row_mask:0xf bank_mask:0xf
v_mov_b32_dpp v57, v29 row_ror:8 row_mask:0xf bank_mask:0xf
v_mov_b32_dpp v58, v30 row_ror:8 row_mask:0xf bank_mask:0xf
v_mov_b32_dpp v59, v31 row_ror:8 row_mask:0xf bank_mask:0xf
v_mov_b32_dpp v60, v28 row_ror:4 row_mask:0xf bank_mask:0xf
v_mov_b32_dpp v61, v29 row_ror:4 row_mask:0xf bank_mask:0xf
v_mov_b32_dpp v62, v30 row_ror:4 row_mask:0xf bank_mask:0xf
v_mov_b32_dpp v63, v31 row_ror:4 row_mask:0xf bank_mask:0xf
v_add_f32 v34, v44, v45
v_add_f32 v33, v46, v47
v_add_f32 v34, v34, v48
v_add_f32 v33, v33, v49
v_add_f32 v34, v34, v50
v_add_f32 v33, v33, v51
v_add_f32 v34, v34, v33
s_nop 1
v_add_f32_dpp v34, v34, v34 row_ror:4 row_mask:0xf bank_mask:0xf
s_nop 0
s_nop 0
v_add_f32_dpp v34, v34, v34 row_ror:8 row_mask:0xf bank_mask:0xf
v_mov_b32 v33, v34
s_nop 1
v_permlane16_swap_b32 v34, v33
v_add_f32 v34, v34, v33
v_mov_b32 v33, v34
s_nop 1
v_permlane32_swap_b32 v34, v33
v_add_f32 v34, v34, v33
ds_write_b32 v22, v34 offset:64
s_mov_b32 s28, 0xffff0000
s_mov_b32 s29, 0
s_mov_b32 s30, 0
s_mov_b32 s31, 0xffff
s_mov_b32 s36, 0
s_mov_b32 s37, 0xffff0000
s_waitcnt vmcnt(32)
v_perm_b32 v96, v132, v128, s63
v_perm_b32 v97, v140, v136, s63
v_perm_b32 v98, v148, v144, s63
v_perm_b32 v99, v156, v152, s63
v_perm_b32 v100, v132, v128, s64
v_perm_b32 v101, v140, v136, s64
v_perm_b32 v102, v148, v144, s64
v_perm_b32 v103, v156, v152, s64
v_mfma_f32_16x16x32_bf16 v[64:67], v[28:31], v[96:99], 0
v_perm_b32 v104, v133, v129, s63
v_perm_b32 v105, v141, v137, s63
v_perm_b32 v106, v149, v145, s63
v_perm_b32 v107, v157, v153, s63
v_mfma_f32_16x16x32_bf16 v[68:71], v[60:63], v[100:103], 0
v_perm_b32 v108, v133, v129, s64
v_perm_b32 v109, v141, v137, s64
v_perm_b32 v110, v149, v145, s64
v_perm_b32 v111, v157, v153, s64
v_mfma_f32_16x16x32_bf16 v[72:75], v[56:59], v[104:107], 0
v_perm_b32 v112, v134, v130, s63
v_perm_b32 v113, v142, v138, s63
v_perm_b32 v114, v150, v146, s63
v_perm_b32 v115, v158, v154, s63
v_mfma_f32_16x16x32_bf16 v[76:79], v[52:55], v[108:111], 0
v_perm_b32 v116, v134, v130, s64
v_perm_b32 v117, v142, v138, s64
v_perm_b32 v118, v150, v146, s64
v_perm_b32 v119, v158, v154, s64
v_mfma_f32_16x16x32_bf16 v[80:83], v[28:31], v[112:115], 0
v_perm_b32 v120, v135, v131, s63
v_perm_b32 v121, v143, v139, s63
v_perm_b32 v122, v151, v147, s63
v_perm_b32 v123, v159, v155, s63
v_mfma_f32_16x16x32_bf16 v[84:87], v[60:63], v[116:119], 0
v_perm_b32 v124, v135, v131, s64
v_perm_b32 v125, v143, v139, s64
v_perm_b32 v126, v151, v147, s64
v_perm_b32 v127, v159, v155, s64
v_mfma_f32_16x16x32_bf16 v[88:91], v[56:59], v[120:123], 0
s_nop 0
v_mfma_f32_16x16x32_bf16 v[92:95], v[52:55], v[124:127], 0
s_waitcnt vmcnt(16)
v_perm_b32 v128, v164, v160, s63
v_perm_b32 v129, v172, v168, s63
v_perm_b32 v130, v180, v176, s63
v_perm_b32 v131, v188, v184, s63
v_perm_b32 v132, v164, v160, s64
v_perm_b32 v133, v172, v168, s64
v_perm_b32 v134, v180, v176, s64
v_perm_b32 v135, v188, v184, s64
v_mfma_f32_16x16x32_bf16 v[64:67], v[52:55], v[128:131], v[64:67]
v_perm_b32 v136, v165, v161, s63
v_perm_b32 v137, v173, v169, s63
v_perm_b32 v138, v181, v177, s63
v_perm_b32 v139, v189, v185, s63
v_mfma_f32_16x16x32_bf16 v[68:71], v[28:31], v[132:135], v[68:71]
v_perm_b32 v140, v165, v161, s64
v_perm_b32 v141, v173, v169, s64
v_perm_b32 v142, v181, v177, s64
v_perm_b32 v143, v189, v185, s64
v_mfma_f32_16x16x32_bf16 v[72:75], v[60:63], v[136:139], v[72:75]
v_perm_b32 v144, v166, v162, s63
v_perm_b32 v145, v174, v170, s63
v_perm_b32 v146, v182, v178, s63
v_perm_b32 v147, v190, v186, s63
v_mfma_f32_16x16x32_bf16 v[76:79], v[56:59], v[140:143], v[76:79]
v_perm_b32 v148, v166, v162, s64
v_perm_b32 v149, v174, v170, s64
v_perm_b32 v150, v182, v178, s64
v_perm_b32 v151, v190, v186, s64
v_mfma_f32_16x16x32_bf16 v[80:83], v[52:55], v[144:147], v[80:83]
v_perm_b32 v152, v167, v163, s63
v_perm_b32 v153, v175, v171, s63
v_perm_b32 v154, v183, v179, s63
v_perm_b32 v155, v191, v187, s63
v_mfma_f32_16x16x32_bf16 v[84:87], v[28:31], v[148:151], v[84:87]
v_perm_b32 v156, v167, v163, s64
v_perm_b32 v157, v175, v171, s64
v_perm_b32 v158, v183, v179, s64
v_perm_b32 v159, v191, v187, s64
v_mfma_f32_16x16x32_bf16 v[88:91], v[60:63], v[152:155], v[88:91]
s_nop 0
v_mfma_f32_16x16x32_bf16 v[92:95], v[56:59], v[156:159], v[92:95]
s_waitcnt lgkmcnt(0)
s_barrier
ds_read_b128 v[36:39], v23
s_waitcnt lgkmcnt(0)
v_max3_f32 v40, v36, v37, v38
v_max_f32 v40, v40, v39
v_sub_f32 v36, v36, v40
v_sub_f32 v37, v37, v40
v_sub_f32 v38, v38, v40
v_sub_f32 v39, v39, v40
v_exp_f32 v36, v36
v_exp_f32 v37, v37
v_exp_f32 v38, v38
v_exp_f32 v39, v39
s_waitcnt vmcnt(8)
v_perm_b32 v160, v196, v192, s63
v_perm_b32 v161, v204, v200, s63
v_perm_b32 v162, v212, v208, s63
v_perm_b32 v163, v220, v216, s63
v_perm_b32 v164, v196, v192, s64
v_perm_b32 v165, v204, v200, s64
v_perm_b32 v166, v212, v208, s64
v_perm_b32 v167, v220, v216, s64
v_mfma_f32_16x16x32_bf16 v[64:67], v[56:59], v[160:163], v[64:67]
v_perm_b32 v168, v197, v193, s63
v_perm_b32 v169, v205, v201, s63
v_perm_b32 v170, v213, v209, s63
v_perm_b32 v171, v221, v217, s63
v_mfma_f32_16x16x32_bf16 v[68:71], v[52:55], v[164:167], v[68:71]
v_perm_b32 v172, v197, v193, s64
v_perm_b32 v173, v205, v201, s64
v_perm_b32 v174, v213, v209, s64
v_perm_b32 v175, v221, v217, s64
v_mfma_f32_16x16x32_bf16 v[72:75], v[28:31], v[168:171], v[72:75]
v_perm_b32 v176, v198, v194, s63
v_perm_b32 v177, v206, v202, s63
v_perm_b32 v178, v214, v210, s63
v_perm_b32 v179, v222, v218, s63
v_mfma_f32_16x16x32_bf16 v[76:79], v[60:63], v[172:175], v[76:79]
v_perm_b32 v180, v198, v194, s64
v_perm_b32 v181, v206, v202, s64
v_perm_b32 v182, v214, v210, s64
v_perm_b32 v183, v222, v218, s64
v_mfma_f32_16x16x32_bf16 v[80:83], v[56:59], v[176:179], v[80:83]
v_perm_b32 v184, v199, v195, s63
v_perm_b32 v185, v207, v203, s63
v_perm_b32 v186, v215, v211, s63
v_perm_b32 v187, v223, v219, s63
v_mfma_f32_16x16x32_bf16 v[84:87], v[52:55], v[180:183], v[84:87]
v_perm_b32 v188, v199, v195, s64
v_perm_b32 v189, v207, v203, s64
v_perm_b32 v190, v215, v211, s64
v_perm_b32 v191, v223, v219, s64
v_mfma_f32_16x16x32_bf16 v[88:91], v[28:31], v[184:187], v[88:91]
s_nop 0
v_mfma_f32_16x16x32_bf16 v[92:95], v[60:63], v[188:191], v[92:95]
s_waitcnt vmcnt(0)
v_perm_b32 v192, v228, v224, s63
v_perm_b32 v193, v236, v232, s63
v_perm_b32 v194, v244, v240, s63
v_perm_b32 v195, v252, v248, s63
v_perm_b32 v196, v228, v224, s64
v_perm_b32 v197, v236, v232, s64
v_perm_b32 v198, v244, v240, s64
v_perm_b32 v199, v252, v248, s64
v_mfma_f32_16x16x32_bf16 v[64:67], v[60:63], v[192:195], v[64:67]
v_perm_b32 v200, v229, v225, s63
v_perm_b32 v201, v237, v233, s63
v_perm_b32 v202, v245, v241, s63
v_perm_b32 v203, v253, v249, s63
v_mfma_f32_16x16x32_bf16 v[68:71], v[56:59], v[196:199], v[68:71]
v_perm_b32 v204, v229, v225, s64
v_perm_b32 v205, v237, v233, s64
v_perm_b32 v206, v245, v241, s64
v_perm_b32 v207, v253, v249, s64
v_mfma_f32_16x16x32_bf16 v[72:75], v[52:55], v[200:203], v[72:75]
v_perm_b32 v208, v230, v226, s63
v_perm_b32 v209, v238, v234, s63
v_perm_b32 v210, v246, v242, s63
v_perm_b32 v211, v254, v250, s63
v_mfma_f32_16x16x32_bf16 v[76:79], v[28:31], v[204:207], v[76:79]
v_cndmask_b32 v64, v64, v68, s[28:29]
v_cndmask_b32 v65, v65, v69, s[28:29]
v_cndmask_b32 v66, v66, v70, s[28:29]
v_cndmask_b32 v67, v67, v71, s[28:29]
v_perm_b32 v212, v230, v226, s64
v_perm_b32 v213, v238, v234, s64
v_perm_b32 v214, v246, v242, s64
v_perm_b32 v215, v254, v250, s64
v_mfma_f32_16x16x32_bf16 v[80:83], v[60:63], v[208:211], v[80:83]
v_cndmask_b32 v64, v64, v72, s[30:31]
v_cndmask_b32 v65, v65, v73, s[30:31]
v_cndmask_b32 v66, v66, v74, s[30:31]
v_cndmask_b32 v67, v67, v75, s[30:31]
v_perm_b32 v216, v231, v227, s63
v_perm_b32 v217, v239, v235, s63
v_perm_b32 v218, v247, v243, s63
v_perm_b32 v219, v255, v251, s63
v_mfma_f32_16x16x32_bf16 v[84:87], v[56:59], v[212:215], v[84:87]
v_cndmask_b32 v64, v64, v76, s[36:37]
v_cndmask_b32 v65, v65, v77, s[36:37]
v_cndmask_b32 v66, v66, v78, s[36:37]
v_cndmask_b32 v67, v67, v79, s[36:37]
ds_write_b128 v11, v[64:67] offset:0
v_perm_b32 v220, v231, v227, s64
v_perm_b32 v221, v239, v235, s64
v_perm_b32 v222, v247, v243, s64
v_perm_b32 v223, v255, v251, s64
v_mfma_f32_16x16x32_bf16 v[88:91], v[52:55], v[216:219], v[88:91]
s_nop 0
v_mfma_f32_16x16x32_bf16 v[92:95], v[28:31], v[220:223], v[92:95]
v_cndmask_b32 v80, v80, v84, s[28:29]
v_cndmask_b32 v81, v81, v85, s[28:29]
v_cndmask_b32 v82, v82, v86, s[28:29]
v_cndmask_b32 v83, v83, v87, s[28:29]
s_nop 1
v_cndmask_b32 v80, v80, v88, s[30:31]
v_cndmask_b32 v81, v81, v89, s[30:31]
v_cndmask_b32 v82, v82, v90, s[30:31]
v_cndmask_b32 v83, v83, v91, s[30:31]
s_lshl_b32 s3, s99, 12
s_lshl_b32 s14, s56, 19
s_add_u32 s14, s14, s3
buffer_load_dwordx4 a[252:255], v26, s[40:43], s14 offen offset:0
buffer_load_dwordx4 a[252:255], v26, s[40:43], s14 offen offset:1024
buffer_load_dwordx4 a[252:255], v26, s[40:43], s14 offen offset:2048
buffer_load_dwordx4 a[252:255], v26, s[40:43], s14 offen offset:3072
v_lshlrev_b32_e64 v35, 7, v0
s_and_b32 s3, s59, 1
s_mul_i32 s3, s3, 458752
s_cmp_ge_u32 s59, 2
s_cbranch_scc1 L_wu9
s_add_u32 s3, s3, s81
v_and_b32 v41, 0x380, v35
s_branch L_wu10
L_wu9:
v_and_b32 v41, 1, v0
v_lshlrev_b32 v41, 7, v41
v_bfe_u32 v42, v0, 1, 1
v_lshl_add_u32 v41, v42, 16, v41
s_add_u32 s14, s65, 327680
v_add_u32_e64 v41, s14, v41
s_sub_u32 s14, s67, 512
v_add_u32 v42, s14, v35
v_cmp_le_u32 vcc, 4, v0
s_nop 1
v_cndmask_b32 v41, v41, v42, vcc
v_mov_b32 v42, s69
v_cmp_le_u32 vcc, 8, v0
s_nop 1
v_cndmask_b32 v41, v41, v42, vcc
L_wu10:
s_mov_b32 exec_lo, 0x1ff
s_mov_b32 exec_hi, 0x0
buffer_load_dword a253, v41, s[52:55], s3 offen sc1
s_getpc_b64 s[14:15]
L_pc:
s_add_u32 s14, s14, L_comb-L_pc
s_addc_u32 s15, s15, 0
s_mov_b64 exec, -1
v_min_u32 v42, L_end-L_comb, v35
s_nop 0
global_load_dword a254, v42, s[14:15]
v_cndmask_b32 v80, v80, v92, s[36:37]
v_cndmask_b32 v81, v81, v93, s[36:37]
v_cndmask_b32 v82, v82, v94, s[36:37]
v_cndmask_b32 v83, v83, v95, s[36:37]
ds_write_b128 v11, v[80:83] offset:1024
L_comb:
s_waitcnt lgkmcnt(0)
s_barrier
ds_read2st64_b32 v[44:45], v20 offset0:0 offset1:1
ds_read2st64_b32 v[46:47], v20 offset0:8 offset1:9
ds_read2st64_b32 v[48:49], v20 offset0:16 offset1:17
ds_read2st64_b32 v[50:51], v20 offset0:24 offset1:25
ds_read_b128 v[52:55], v23 offset:64
s_waitcnt lgkmcnt(1)
v_mul_f32 v44, v36, v44
v_mul_f32 v45, v36, v45
v_fmac_f32 v44, v37, v46
v_fmac_f32 v45, v37, v47
v_fmac_f32 v44, v38, v48
v_fmac_f32 v45, v38, v49
v_fmac_f32 v44, v39, v50
v_fmac_f32 v45, v39, v51
v_cvt_pk_bf16_f32 v44, v44, v45
s_cmp_eq_u32 s60, 0
s_cbranch_scc1 L_ps11
buffer_store_dword v44, v21, s[52:55], s75 offen
L_pe12:
s_cmp_lg_u32 s59, 0
s_cbranch_scc1 L_sk13
s_waitcnt lgkmcnt(0)
v_mul_f32 v41, v36, v52
v_fmac_f32 v41, v37, v53
v_fmac_f32 v41, v38, v54
v_fmac_f32 v41, v39, v55
v_lshlrev_b32 v46, 3, v0
s_mov_b32 exec_lo, 0x10001
s_mov_b32 exec_hi, 0x10001
s_cmp_eq_u32 s60, 0
s_cbranch_scc1 L_ps14
buffer_store_dwordx2 v[40:41], v46, s[52:55], s67 offen
L_pe15:
s_mov_b64 exec, -1
L_sk13:
s_cmp_lg_u32 s61, 0
s_cbranch_scc1 L_as19
v_lshrrev_b32 v56, 2, v0
v_and_b32 v57, 3, v0
v_lshlrev_b32 v58, 4, v57
v_lshl_add_u32 v225, v56, 10, v58
s_lshl_b32 s14, s56, 19
s_lshl_b32 s3, s59, 17
s_add_u32 s14, s14, s3
s_lshl_b32 s3, s58, 6
s_add_u32 s14, s14, s3
s_add_u32 m0, s80, 0
s_add_u32 s3, s14, 0
buffer_load_dwordx4 v225, s[40:43], s3 offen lds
s_add_u32 m0, s80, 1024
s_add_u32 s3, s14, 16384
buffer_load_dwordx4 v225, s[40:43], s3 offen lds
s_add_u32 m0, s80, 2048
s_add_u32 s3, s14, 32768
buffer_load_dwordx4 v225, s[40:43], s3 offen lds
s_add_u32 m0, s80, 3072
s_add_u32 s3, s14, 49152
buffer_load_dwordx4 v225, s[40:43], s3 offen lds
s_add_u32 m0, s80, 4096
s_add_u32 s3, s14, 65536
buffer_load_dwordx4 v225, s[40:43], s3 offen lds
s_add_u32 m0, s80, 5120
s_add_u32 s3, s14, 81920
buffer_load_dwordx4 v225, s[40:43], s3 offen lds
s_add_u32 m0, s80, 6144
s_add_u32 s3, s14, 98304
buffer_load_dwordx4 v225, s[40:43], s3 offen lds
s_add_u32 m0, s80, 7168
s_add_u32 s3, s14, 114688
buffer_load_dwordx4 v225, s[40:43], s3 offen lds
buffer_load_dwordx2 v[44:45], v6, s[52:55], s68 offen sc1
buffer_load_dwordx4 v[28:31], v26, s[52:55], s76 offen offset:0 sc1
buffer_load_dwordx4 v[32:35], v26, s[52:55], s76 offen offset:1024 sc1
buffer_load_dwordx4 v[36:39], v26, s[52:55], s76 offen offset:2048 sc1
buffer_load_dwordx4 v[40:43], v26, s[52:55], s76 offen offset:3072 sc1
v_lshrrev_b32 v58, 1, v0
v_mul_u32_u24 v224, 3584, v58
v_and_b32_e64 v58, 1, v0
v_lshl_add_u32 v224, v58, 4, v224
v_and_b32 v56, 3, v56
v_lshrrev_b32 v58, 4, v0
v_lshlrev_b32 v57, 3, v57
v_and_b32 v59, 1, v56
v_lshrrev_b32_e64 v60, 1, v56
v_lshl_add_u32 v59, v60, 3, v59
v_lshl_add_u32 v59, v58, 5, v59
v_lshl_add_u32 v59, v59, 6, v57
v_add_u32_e64 v228, s80, v59
v_lshl_add_u32 v56, v58, 3, v56
v_lshl_add_u32 v58, v56, 5, v57
v_add_u32_e64 v226, s80, v58
v_lshl_add_u32 v58, v56, 6, v57
s_and_b32 s3, s59, 1
s_lshl_b32 s3, s3, 5
s_add_u32 s3, s3, 0
v_add_u32 v227, s3, v58
v_mov_b32_dpp v232, v12 row_ror:8 row_mask:0xf bank_mask:0xf
v_mov_b32_dpp v233, v13 row_ror:8 row_mask:0xf bank_mask:0xf
v_mov_b32_dpp v234, v14 row_ror:8 row_mask:0xf bank_mask:0xf
v_mov_b32_dpp v235, v15 row_ror:8 row_mask:0xf bank_mask:0xf
s_waitcnt vmcnt(5)
ds_read_b64_tr_b16 a[160:161], v228 offset:0
ds_read_b64_tr_b16 a[162:163], v228 offset:1024
ds_read_b64_tr_b16 a[164:165], v228 offset:128
ds_read_b64_tr_b16 a[166:167], v228 offset:1152
ds_read_b64_tr_b16 a[168:169], v228 offset:256
ds_read_b64_tr_b16 a[170:171], v228 offset:1280
ds_read_b64_tr_b16 a[172:173], v228 offset:384
ds_read_b64_tr_b16 a[174:175], v228 offset:1408
ds_read_b64_tr_b16 a[176:177], v228 offset:32
ds_read_b64_tr_b16 a[178:179], v228 offset:1056
ds_read_b64_tr_b16 a[180:181], v228 offset:160
ds_read_b64_tr_b16 a[182:183], v228 offset:1184
ds_read_b64_tr_b16 a[184:185], v228 offset:288
ds_read_b64_tr_b16 a[186:187], v228 offset:1312
ds_read_b64_tr_b16 a[188:189], v228 offset:416
ds_read_b64_tr_b16 a[190:191], v228 offset:1440
s_waitcnt lgkmcnt(0)
s_branch L_pa018
L_as19:
s_sleep 4
L_pa16:
buffer_load_dwordx2 v[44:45], v6, s[52:55], s68 offen sc1
buffer_load_dwordx4 v[28:31], v26, s[52:55], s76 offen offset:0 sc1
buffer_load_dwordx4 v[32:35], v26, s[52:55], s76 offen offset:1024 sc1
buffer_load_dwordx4 v[36:39], v26, s[52:55], s76 offen offset:2048 sc1
buffer_load_dwordx4 v[40:43], v26, s[52:55], s76 offen offset:3072 sc1
L_pa018:
s_waitcnt vmcnt(4)
v_cmp_u_f32 vcc, v44, v45
v_max_f32_dpp v57, v44, v44 quad_perm:[1,0,3,2] row_mask:0xf bank_mask:0xf
s_cbranch_vccnz L_aretry
s_nop 0
v_max_f32_dpp v57, v57, v57 quad_perm:[2,3,0,1] row_mask:0xf bank_mask:0xf
v_mov_b32 v58, v57
s_waitcnt vmcnt(3)
v_mfma_f32_16x16x32_bf16 v[48:51], v[28:31], a[160:163], 0
v_permlane16_swap_b32 v57, v58
v_mfma_f32_16x16x32_bf16 v[52:55], v[28:31], a[176:179], 0
v_max_f32_e64 v57, v57, v58
s_waitcnt vmcnt(2)
v_mfma_f32_16x16x32_bf16 v[48:51], v[32:35], a[164:167], v[48:51]
v_mov_b32_e64 v58, v57
v_mfma_f32_16x16x32_bf16 v[52:55], v[32:35], a[180:183], v[52:55]
s_nop 0
v_permlane32_swap_b32 v57, v58
s_waitcnt vmcnt(1)
v_mfma_f32_16x16x32_bf16 v[48:51], v[36:39], a[168:171], v[48:51]
v_max_f32 v57, v57, v58
v_mfma_f32_16x16x32_bf16 v[52:55], v[36:39], a[184:187], v[52:55]
v_sub_f32 v57, v44, v57
s_waitcnt vmcnt(0)
v_mfma_f32_16x16x32_bf16 v[48:51], v[40:43], a[172:175], v[48:51]
v_exp_f32 v57, v57
s_nop 0
v_mul_f32_e64 v58, v57, v45
v_mfma_f32_16x16x32_bf16 v[52:55], v[40:43], a[188:191], v[52:55]
s_nop 0
v_add_f32_dpp v58, v58, v58 quad_perm:[1,0,3,2] row_mask:0xf bank_mask:0xf
s_nop 1
v_add_f32_dpp v58, v58, v58 quad_perm:[2,3,0,1] row_mask:0xf bank_mask:0xf
v_mov_b32_e64 v59, v58
v_mul_f32_dpp v60, v57, v48 quad_perm:[0,0,0,0] row_mask:0xf bank_mask:0xf
s_nop 0
v_permlane16_swap_b32 v58, v59
v_mul_f32_dpp v61, v57, v52 quad_perm:[0,0,0,0] row_mask:0xf bank_mask:0xf
v_fmac_f32_dpp v60, v57, v49 quad_perm:[1,1,1,1] row_mask:0xf bank_mask:0xf
v_add_f32_e64 v58, v58, v59
v_fmac_f32_dpp v61, v57, v53 quad_perm:[1,1,1,1] row_mask:0xf bank_mask:0xf
v_fmac_f32_dpp v60, v57, v50 quad_perm:[2,2,2,2] row_mask:0xf bank_mask:0xf
v_mov_b32_e64 v59, v58
v_fmac_f32_dpp v61, v57, v54 quad_perm:[2,2,2,2] row_mask:0xf bank_mask:0xf
v_fmac_f32_dpp v60, v57, v51 quad_perm:[3,3,3,3] row_mask:0xf bank_mask:0xf
v_permlane32_swap_b32 v58, v59
v_fmac_f32_dpp v61, v57, v55 quad_perm:[3,3,3,3] row_mask:0xf bank_mask:0xf
v_add_f32 v58, v58, v59
v_rcp_f32 v58, v58
v_permlane32_swap_b32 v60, v61
v_add_f32 v60, v60, v61
v_mov_b32 v61, v60
s_nop 1
v_permlane16_swap_b32 v60, v61
v_add_f32 v60, v60, v61
v_mul_f32 v60, v60, v58
v_cmp_u_f32_e64 vcc, v60, v60
ds_write_b32 v4, v60
s_cbranch_vccz L_paok17
L_aretry:
s_waitcnt vmcnt(0)
s_sub_u32 s62, s62, 1
s_cbranch_scc0 L_pa16
s_mov_b32 s62, 0
L_paok17:
s_cmp_lg_u32 s61, 0
s_cbranch_scc1 L_sk20
s_mul_i32 s14, s99, 14336
s_mul_i32 s3, s56, 448
s_add_u32 s14, s14, s3
v_lshrrev_b32_e64 v62, 5, v0
v_mul_u32_u24 v62, 3584, v62
v_and_b32_e64 v63, 31, v0
v_lshl_add_u32 v62, v63, 4, v62
s_add_u32 s3, s14, 7168
s_mov_b32 exec_lo, 0xfffffff
s_mov_b32 exec_hi, 0xfffffff
buffer_load_dwordx4 a[252:255], v62, s[44:47], s14 offen
buffer_load_dwordx4 a[252:255], v62, s[44:47], s3 offen
s_mul_i32 s14, s99, 1792
s_mul_i32 s3, s56, 229376
s_add_u32 s14, s14, s3
s_mov_b32 exec_lo, 0xffffffff
s_mov_b32 exec_hi, 0xffffff
buffer_load_dwordx4 a[252:255], v26, s[48:51], s14 offen
buffer_load_dwordx4 a[252:255], v26, s[48:51], s14 offen offset:896
s_mov_b64 exec, -1
L_sk20:
s_waitcnt lgkmcnt(0)
s_barrier
s_cmp_lg_u32 s59, 0
s_cbranch_scc1 L_y21
ds_read_b128 v[28:31], v3 offset:1024
s_mov_b32 exec_lo, 0xffffffff
s_mov_b32 exec_hi, 0x0
s_waitcnt lgkmcnt(0)
v_add_f32 v28, v28, v29
v_add_f32 v30, v30, v31
v_add_f32_e64 v28, v28, v30
v_cvt_pk_bf16_f32 v28, v28, v28
buffer_store_short v28, v10, s[52:55], s71 offen sc1
s_mov_b64 exec, -1
s_branch L_y222
L_y21:
s_sleep 2
L_y222:
s_cmp_lg_u32 s11, 0
s_cbranch_scc1 L_cen2
L_cen2_back:
s_cmp_lg_u32 s61, 0
s_cbranch_scc1 L_b23
s_mul_i32 s14, s59, 458752
s_mul_i32 s3, s56, 448
s_add_u32 s14, s14, s3
s_lshl_b32 s3, s98, 5
s_add_u32 s14, s14, s3
s_add_u32 m0, s80, 8192
s_add_u32 s3, s14, 0
buffer_load_dwordx4 v224, s[44:47], s3 offen lds
s_add_u32 m0, s80, 9216
s_add_u32 s3, s14, 114688
buffer_load_dwordx4 v224, s[44:47], s3 offen lds
s_add_u32 m0, s80, 10240
s_add_u32 s3, s14, 229376
buffer_load_dwordx4 v224, s[44:47], s3 offen lds
s_add_u32 m0, s80, 11264
s_add_u32 s3, s14, 344064
buffer_load_dwordx4 v224, s[44:47], s3 offen lds
s_mul_i32 s14, s56, 229376
s_lshl_b32 s3, s58, 6
s_add_u32 s14, s14, s3
s_lshl_b32 s3, s59, 14
s_add_u32 s14, s14, s3
s_lshl_b32 s15, s59, 10
s_sleep 10
s_branch L_b24
L_b23:
s_sleep 14
L_b24:
L_gb25:
buffer_load_dwordx4 v[32:35], v7, s[52:55], s72 offen sc1
buffer_load_dwordx4 v[36:39], v7, s[52:55], s77 offen sc1
s_cmp_eq_u32 s59, s101
s_cbranch_scc1 L_gbo28
s_waitcnt vmcnt(1)
v_mfma_f32_16x16x32_bf16 v[40:43], v[12:15], v[32:35], v[16:19]
s_waitcnt vmcnt(0)
v_mfma_f32_16x16x32_bf16 v[40:43], v[12:15], v[36:39], v[40:43]
s_branch L_gbck27
L_gbo28:
s_add_u32 s3, s4, 4096
buffer_load_dwordx4 v[44:47], v7, s[52:55], s4 offen sc1
buffer_load_dwordx4 v[48:51], v7, s[52:55], s3 offen sc1
s_waitcnt vmcnt(3)
s_nop 2
v_mfma_f32_16x16x32_bf16 v[40:43], v[12:15], v[32:35], v[16:19]
s_waitcnt vmcnt(2)
v_mfma_f32_16x16x32_bf16 v[40:43], v[12:15], v[36:39], v[40:43]
s_waitcnt vmcnt(1)
v_mfma_f32_16x16x32_bf16 v[40:43], v[232:235], v[44:47], v[40:43]
s_waitcnt vmcnt(0)
v_mfma_f32_16x16x32_bf16 v[40:43], v[232:235], v[48:51], v[40:43]
L_gbck27:
s_nop 3
s_cmp_lg_u32 s61, 0
s_cbranch_scc1 L_sk29
ds_read_b64_tr_b16 a[192:193], v226 offset:8192
ds_read_b64_tr_b16 a[194:195], v226 offset:8320
ds_read_b64_tr_b16 a[196:197], v226 offset:9216
ds_read_b64_tr_b16 a[198:199], v226 offset:9344
ds_read_b64_tr_b16 a[200:201], v226 offset:10240
ds_read_b64_tr_b16 a[202:203], v226 offset:10368
ds_read_b64_tr_b16 a[204:205], v226 offset:11264
ds_read_b64_tr_b16 a[206:207], v226 offset:11392
L_sk29:
s_nop 1
v_cmp_u_f32 vcc, v40, v40
s_cbranch_vccz L_gbok26
s_sub_u32 s62, s62, 1
s_cbranch_scc0 L_gb25
s_mov_b32 s62, 0
L_gbok26:
v_cvt_pk_bf16_f32 v28, v40, v41
v_cvt_pk_bf16_f32 v29, v42, v43
s_cmp_ge_u32 s98, 14
s_mov_b32 exec_lo, 0xffffffff
s_mov_b32 exec_hi, 0x0
ds_write_b64 v1, v[28:29]
s_mov_b64 exec, -1
ds_read_b128 v[32:35], v2 offset:0
ds_read_b128 v[36:39], v2 offset:64
ds_read_b128 v[40:43], v2 offset:128
ds_read_b128 v[44:47], v2 offset:192
v_lshlrev_b32_e64 v16, 16, v28
v_and_b32 v17, 0xffff0000, v28
v_lshlrev_b32_e64 v18, 16, v29
v_and_b32 v19, 0xffff0000, v29
s_cbranch_scc1 L_nof30
v_add_f32 v30, v16, v17
v_mul_f32 v31, v16, v16
v_add_f32 v56, v18, v19
v_fmac_f32 v31, v17, v17
v_add_f32 v30, v30, v56
v_fmac_f32 v31, v18, v18
v_fmac_f32 v31, v19, v19
v_add_f32_dpp v30, v30, v30 row_ror:8 row_mask:0xf bank_mask:0xf
s_nop 0
v_add_f32_dpp v31, v31, v31 row_ror:8 row_mask:0xf bank_mask:0xf
v_add_f32_dpp v30, v30, v30 row_ror:4 row_mask:0xf bank_mask:0xf
s_nop 0
v_add_f32_dpp v31, v31, v31 row_ror:4 row_mask:0xf bank_mask:0xf
s_waitcnt lgkmcnt(0)
v_mfma_f32_16x16x32_bf16 v[48:51], v[32:35], a[192:195], 0
v_add_f32_dpp v30, v30, v30 row_ror:2 row_mask:0xf bank_mask:0xf
v_add_f32_dpp v31, v31, v31 row_ror:2 row_mask:0xf bank_mask:0xf
v_mfma_f32_16x16x32_bf16 v[48:51], v[36:39], a[196:199], v[48:51]
v_add_f32_dpp v30, v30, v30 row_ror:1 row_mask:0xf bank_mask:0xf
v_add_f32_dpp v31, v31, v31 row_ror:1 row_mask:0xf bank_mask:0xf
v_mfma_f32_16x16x32_bf16 v[48:51], v[40:43], a[200:203], v[48:51]
v_add_f32_dpp v30, v30, v30 row_bcast:15 row_mask:0xa bank_mask:0xf
v_add_f32_dpp v31, v31, v31 row_bcast:15 row_mask:0xa bank_mask:0xf
v_mfma_f32_16x16x32_bf16 v[48:51], v[44:47], a[204:207], v[48:51]
s_mov_b32 exec_lo, 0x10000
s_mov_b32 exec_hi, 0x0
ds_write2_b32 v24, v30, v31 offset0:8 offset1:12
s_mov_b64 exec, -1
s_nop 3
ds_write_b32 v3, v48 offset:0
L_nof30:
s_cmp_lg_u32 s61, 0
s_cbranch_scc1 L_sk31
s_add_u32 m0, s15, 0
s_add_u32 s3, s14, 0
buffer_load_dwordx4 v225, s[48:51], s3 offen lds
s_add_u32 m0, s15, 4096
s_add_u32 s3, s14, 65536
buffer_load_dwordx4 v225, s[48:51], s3 offen lds
s_add_u32 m0, s15, 8192
s_add_u32 s3, s14, 131072
buffer_load_dwordx4 v225, s[48:51], s3 offen lds
s_add_u32 m0, s15, 12288
s_add_u32 s3, s14, 196608
buffer_load_dwordx4 v225, s[48:51], s3 offen lds
L_sk31:
s_waitcnt vmcnt(63) lgkmcnt(0)
s_barrier
s_cmp_lg_u32 s59, 0
s_cbranch_scc1 L_h32
s_cmp_ge_u32 s98, 14
s_cbranch_scc1 L_h32
ds_read_b128 v[36:39], v24 offset:32
ds_read_b128 v[40:43], v24 offset:48
ds_read_b128 v[28:31], v3 offset:0
ds_read_b128 v[32:35], v3 offset:512
s_mov_b32 s3, 0x3b000000
v_mov_b32 v44, 0x3727c5ac
s_mov_b32 exec_lo, 0xffff
s_mov_b32 exec_hi, 0x0
s_waitcnt lgkmcnt(2)
v_add_f32 v36, v36, v37
v_add_f32 v38, v38, v39
v_add_f32 v40, v40, v41
v_add_f32 v42, v42, v43
v_add_f32 v36, v36, v38
v_add_f32 v40, v40, v42
v_mul_f32_e64 v36, s3, v36
v_fma_f32 v41, s3, v40, v44
s_waitcnt lgkmcnt(0)
v_add_f32 v32, v32, v33
v_fma_f32 v41, -v36, v36, v41
v_add_f32 v34, v34, v35
v_max_f32 v41, v44, v41
v_add_f32 v28, v28, v29
v_rsq_f32 v41, v41
v_add_f32 v30, v30, v31
v_add_f32 v32, v32, v34
v_add_f32_e64 v28, v28, v30
v_mul_f32 v42, 0xbfb8aa3b, v41
v_fma_f32 v28, -v36, v32, v28
v_mul_f32 v29, v28, v42
v_exp_f32 v29, v29
v_mul_f32 v28, v28, v41
v_add_f32 v29, 1.0, v29
v_rcp_f32 v29, v29
s_cmp_eq_u32 s60, 0
v_mul_f32_e64 v28, v28, v29
v_cvt_pk_bf16_f32 v28, v28, v28
s_cmp_eq_u32 s60, 0
s_cbranch_scc1 L_ps33
buffer_store_short v28, v10, s[52:55], s69 offen
L_pe34:
s_mov_b64 exec, -1
L_h32:
s_cmp_lg_u32 s61, 0
s_cbranch_scc1 L_sk35
s_waitcnt vmcnt(0)
s_barrier
L_sk35:
s_cmp_lt_u32 s59, 2
s_cbranch_scc1 L_pdsk38
s_cmp_lg_u32 s61, 0
s_cbranch_scc1 L_ds39
ds_read_b64_tr_b16 a[208:209], v227 offset:0
ds_read_b64_tr_b16 a[210:211], v227 offset:256
ds_read_b64_tr_b16 a[212:213], v227 offset:2048
ds_read_b64_tr_b16 a[214:215], v227 offset:2304
ds_read_b64_tr_b16 a[216:217], v227 offset:4096
ds_read_b64_tr_b16 a[218:219], v227 offset:4352
ds_read_b64_tr_b16 a[220:221], v227 offset:6144
ds_read_b64_tr_b16 a[222:223], v227 offset:6400
ds_read_b64_tr_b16 a[224:225], v227 offset:8192
ds_read_b64_tr_b16 a[226:227], v227 offset:8448
ds_read_b64_tr_b16 a[228:229], v227 offset:10240
ds_read_b64_tr_b16 a[230:231], v227 offset:10496
ds_read_b64_tr_b16 a[232:233], v227 offset:12288
ds_read_b64_tr_b16 a[234:235], v227 offset:12544
s_waitcnt lgkmcnt(0)
s_branch L_pd36
L_ds39:
s_sleep 6
L_pd36:
s_mov_b32 exec_lo, 0x10001
s_mov_b32 exec_hi, 0x10001
buffer_load_dwordx4 v[28:31], v8, s[52:55], s70 offen offset:0 sc1
buffer_load_dwordx4 v[32:35], v8, s[52:55], s70 offen offset:64 sc1
buffer_load_dwordx4 v[36:39], v8, s[52:55], s70 offen offset:128 sc1
buffer_load_dwordx4 v[40:43], v8, s[52:55], s70 offen offset:192 sc1
buffer_load_dwordx4 v[44:47], v8, s[52:55], s70 offen offset:256 sc1
buffer_load_dwordx4 v[48:51], v8, s[52:55], s70 offen offset:320 sc1
buffer_load_dwordx4 v[52:55], v8, s[52:55], s70 offen offset:384 sc1
s_waitcnt vmcnt(6)
v_mfma_f32_16x16x32_bf16 v[56:59], a[208:211], v[28:31], 0
s_waitcnt vmcnt(5)
v_mfma_f32_16x16x32_bf16 v[56:59], a[212:215], v[32:35], v[56:59]
s_waitcnt vmcnt(4)
v_mfma_f32_16x16x32_bf16 v[56:59], a[216:219], v[36:39], v[56:59]
s_waitcnt vmcnt(3)
v_mfma_f32_16x16x32_bf16 v[56:59], a[220:223], v[40:43], v[56:59]
s_waitcnt vmcnt(2)
v_mfma_f32_16x16x32_bf16 v[56:59], a[224:227], v[44:47], v[56:59]
s_waitcnt vmcnt(1)
v_mfma_f32_16x16x32_bf16 v[56:59], a[228:231], v[48:51], v[56:59]
s_waitcnt vmcnt(0)
v_mfma_f32_16x16x32_bf16 v[56:59], a[232:235], v[52:55], v[56:59]
s_nop 7
v_cmp_u_f32_e64 vcc, v56, v56
v_cvt_pk_bf16_f32 v56, v56, v57
v_cvt_pk_bf16_f32 v57, v58, v59
s_cbranch_vccz L_pdok37
s_sub_u32 s62, s62, 1
s_cbranch_scc0 L_pd36
s_mov_b32 s62, 0
L_pdok37:
s_mov_b32 exec_lo, 0x10001
s_mov_b32 exec_hi, 0x10001
buffer_store_dwordx2 v[56:57], v25, s[52:55], s73 offen sc1
s_mov_b64 exec, -1
L_pdsk38:
s_cmp_lg_u32 s61, 0
s_cbranch_scc1 L_final
s_barrier
s_sleep 16
L_ge40:
buffer_load_dwordx4 v[32:35], v7, s[52:55], s74 offen sc1
buffer_load_dwordx4 v[36:39], v7, s[52:55], s78 offen sc1
s_cmp_eq_u32 s59, s101
s_cbranch_scc1 L_geo43
s_waitcnt vmcnt(1)
v_mfma_f32_16x16x32_bf16 v[40:43], v[12:15], v[32:35], v[16:19]
s_waitcnt vmcnt(0)
v_mfma_f32_16x16x32_bf16 v[40:43], v[12:15], v[36:39], v[40:43]
s_nop 0
s_nop 5
s_branch L_geck42
L_geo43:
s_add_u32 s3, s5, 4096
buffer_load_dwordx4 v[44:47], v7, s[52:55], s5 offen sc1
buffer_load_dwordx4 v[48:51], v7, s[52:55], s3 offen sc1
s_waitcnt vmcnt(3)
v_mfma_f32_16x16x32_bf16 v[40:43], v[12:15], v[32:35], v[16:19]
s_waitcnt vmcnt(2)
v_mfma_f32_16x16x32_bf16 v[40:43], v[12:15], v[36:39], v[40:43]
s_waitcnt vmcnt(1)
v_mfma_f32_16x16x32_bf16 v[40:43], v[232:235], v[44:47], v[40:43]
s_waitcnt vmcnt(0)
v_mfma_f32_16x16x32_bf16 v[40:43], v[232:235], v[48:51], v[40:43]
L_geck42:
s_nop 7
v_cmp_u_f32 vcc, v40, v40
s_cbranch_vccz L_geok41
s_sub_u32 s62, s62, 1
s_cbranch_scc0 L_ge40
s_mov_b32 s62, 0
L_geok41:
v_cvt_pk_bf16_f32 v28, v40, v41
v_cvt_pk_bf16_f32 v29, v42, v43
s_cmp_lg_u32 s59, s101
s_cbranch_scc1 L_sk44
ds_write_b64 v27, v[28:29]
L_sk44:
v_accvgpr_read_b32 v57, a238
s_add_u32 s52, s52, 458752
s_addc_u32 s53, s53, 0
s_mov_b32 s54, 0x81000
s_mov_b32 s61, 1
s_lshl_b32 s3, s59, 6
s_add_u32 s3, s3, s65
s_add_u32 s3, s3, 327680
s_waitcnt lgkmcnt(0)
s_barrier
ds_read_b128 v[32:35], v57 offset:0
ds_read_b128 v[36:39], v57 offset:64
ds_read_b128 v[40:43], v57 offset:128
ds_read_b128 v[44:47], v57 offset:192
v_lshlrev_b32_e64 v16, 16, v28
v_and_b32 v17, 0xffff0000, v28
v_lshlrev_b32_e64 v18, 16, v29
v_and_b32 v19, 0xffff0000, v29
v_add_f32 v30, v16, v17
v_mul_f32 v31, v16, v16
v_add_f32 v56, v18, v19
v_fmac_f32 v31, v17, v17
v_add_f32 v30, v30, v56
v_fmac_f32 v31, v18, v18
v_fmac_f32 v31, v19, v19
s_waitcnt lgkmcnt(3)
v_mfma_f32_16x16x32_bf16 v[48:51], v[32:35], a[128:131], 0
s_waitcnt lgkmcnt(2)
v_mfma_f32_16x16x32_bf16 v[48:51], v[36:39], a[132:135], v[48:51]
s_waitcnt lgkmcnt(1)
v_mfma_f32_16x16x32_bf16 v[48:51], v[40:43], a[136:139], v[48:51]
s_waitcnt lgkmcnt(0)
v_mfma_f32_16x16x32_bf16 v[48:51], v[44:47], a[140:143], v[48:51]
v_add_f32_dpp v30, v30, v30 row_ror:8 row_mask:0xf bank_mask:0xf
v_add_f32_dpp v31, v31, v31 row_ror:8 row_mask:0xf bank_mask:0xf
s_nop 0
v_add_f32_dpp v30, v30, v30 row_ror:4 row_mask:0xf bank_mask:0xf
v_add_f32_dpp v31, v31, v31 row_ror:4 row_mask:0xf bank_mask:0xf
s_mov_b32 exec_lo, 0xffffffff
s_mov_b32 exec_hi, 0x0
s_cmp_eq_u32 s60, 0
s_cbranch_scc1 L_ps45
buffer_store_dword v48, v5, s[52:55], s3 offen
L_pe46:
s_mov_b64 exec, -1
v_add_f32_dpp v30, v30, v30 row_ror:2 row_mask:0xf bank_mask:0xf
v_add_f32_dpp v31, v31, v31 row_ror:2 row_mask:0xf bank_mask:0xf
s_nop 0
v_add_f32_dpp v30, v30, v30 row_ror:1 row_mask:0xf bank_mask:0xf
v_add_f32_dpp v31, v31, v31 row_ror:1 row_mask:0xf bank_mask:0xf
s_nop 0
v_add_f32_dpp v30, v30, v30 row_bcast:15 row_mask:0xa bank_mask:0xf
v_add_f32_dpp v31, v31, v31 row_bcast:15 row_mask:0xa bank_mask:0xf
s_mov_b32 exec_lo, 0x10000
s_mov_b32 exec_hi, 0x0
ds_write2_b32 v24, v30, v31 offset0:0 offset1:4
s_mov_b64 exec, -1
v_mov_b32 v58, 152064
s_waitcnt lgkmcnt(0)
s_barrier
ds_read_b128 v[52:55], v58
ds_read_b128 v[56:59], v58 offset:16
v_lshlrev_b32 v60, 3, v0
v_add_u32 v61, 4096, v60
buffer_load_dwordx2 v[44:45], v60, s[52:55], s66 offen offset:0 sc1
buffer_load_dwordx2 v[46:47], v60, s[52:55], s66 offen offset:2048 sc1
buffer_load_dwordx2 v[48:49], v61, s[52:55], s66 offen offset:0 sc1
buffer_load_dwordx2 v[50:51], v61, s[52:55], s66 offen offset:2048 sc1
s_waitcnt lgkmcnt(0)
v_add_f32 v52, v52, v53
v_add_f32 v54, v54, v55
v_add_f32 v56, v56, v57
v_add_f32 v58, v58, v59
v_add_f32 v52, v52, v54
v_add_f32_e64 v56, v56, v58
v_mul_f32 v62, 0x3b000000, v52
v_mul_f32 v56, 0x3b000000, v56
v_fma_f32 v56, -v62, v62, v56
v_max_f32_e64 v56, 0, v56
v_add_f32 v56, 0x3727c5ac, v56
v_rsq_f32 v56, v56
s_nop 0
v_mul_f32 v63, 0x3e0293ee, v56
s_mov_b32 s101, 99
v_accvgpr_read_b32 v56, a236
v_accvgpr_read_b32 v57, a237
v_accvgpr_read_b32 v59, a239
s_branch L_pg049
L_pg47:
buffer_load_dwordx2 v[44:45], v60, s[52:55], s66 offen offset:0 sc1
buffer_load_dwordx2 v[46:47], v60, s[52:55], s66 offen offset:2048 sc1
buffer_load_dwordx2 v[48:49], v61, s[52:55], s66 offen offset:0 sc1
buffer_load_dwordx2 v[50:51], v61, s[52:55], s66 offen offset:2048 sc1
L_pg049:
s_waitcnt vmcnt(0)
v_add_f32 v44, v44, v46
v_add_f32 v45, v45, v47
v_add_f32 v48, v48, v50
v_add_f32 v49, v49, v51
v_add_f32 v44, v44, v48
v_add_f32 v45, v45, v49
v_cmp_u_f32_e64 vcc, v44, v45
s_cbranch_vccz L_pgok48
s_sub_u32 s62, s62, 1
s_cbranch_scc0 L_pg47
s_mov_b32 s62, 0
L_pgok48:
v_fma_f32 v44, -v62, v56, v44
v_fma_f32 v45, -v62, v57, v45
v_mul_f32 v44, v44, v63
v_mul_f32 v45, v45, v63
v_cvt_pk_bf16_f32 v44, v44, v45
ds_write_b32 v59, v44
s_waitcnt lgkmcnt(0)
s_barrier
ds_read_b128 v[28:31], v9 offset:0
ds_read_b128 v[32:35], v9 offset:256
ds_read_b128 v[36:39], v9 offset:512
ds_read_b128 v[40:43], v9 offset:768
s_waitcnt lgkmcnt(0)
v_mfma_f32_16x16x32_bf16 v[44:47], a[0:3], v[28:31], 0
v_mfma_f32_16x16x32_bf16 v[44:47], a[4:7], v[32:35], v[44:47]
v_mfma_f32_16x16x32_bf16 v[44:47], a[8:11], v[36:39], v[44:47]
v_mfma_f32_16x16x32_bf16 v[44:47], a[12:15], v[40:43], v[44:47]
v_mfma_f32_16x16x32_bf16 v[48:51], a[16:19], v[28:31], 0
v_mfma_f32_16x16x32_bf16 v[48:51], a[20:23], v[32:35], v[48:51]
v_mfma_f32_16x16x32_bf16 v[48:51], a[24:27], v[36:39], v[48:51]
v_mfma_f32_16x16x32_bf16 v[48:51], a[28:31], v[40:43], v[48:51]
v_mfma_f32_16x16x32_bf16 v[60:63], a[32:35], v[28:31], 0
v_mfma_f32_16x16x32_bf16 v[60:63], a[36:39], v[32:35], v[60:63]
v_mfma_f32_16x16x32_bf16 v[60:63], a[40:43], v[36:39], v[60:63]
v_mfma_f32_16x16x32_bf16 v[60:63], a[44:47], v[40:43], v[60:63]
v_mfma_f32_16x16x32_bf16 v[52:55], a[48:51], v[28:31], 0
v_mfma_f32_16x16x32_bf16 v[52:55], a[52:55], v[32:35], v[52:55]
v_mfma_f32_16x16x32_bf16 v[52:55], a[56:59], v[36:39], v[52:55]
v_mfma_f32_16x16x32_bf16 v[52:55], a[60:63], v[40:43], v[52:55]
v_mfma_f32_16x16x32_bf16 v[56:59], a[64:67], v[28:31], 0
s_nop 2
v_mov_b32_dpp v44, v60 quad_perm:[0,1,2,3] row_mask:0xf bank_mask:0x2
v_mfma_f32_16x16x32_bf16 v[56:59], a[68:71], v[32:35], v[56:59]
v_mov_b32_dpp v45, v61 quad_perm:[0,1,2,3] row_mask:0xf bank_mask:0x2
v_mfma_f32_16x16x32_bf16 v[56:59], a[72:75], v[36:39], v[56:59]
v_mov_b32_dpp v46, v62 quad_perm:[0,1,2,3] row_mask:0xf bank_mask:0x2
v_mfma_f32_16x16x32_bf16 v[56:59], a[76:79], v[40:43], v[56:59]
v_mov_b32_dpp v47, v63 quad_perm:[0,1,2,3] row_mask:0xf bank_mask:0x2
v_mfma_f32_16x16x32_bf16 v[60:63], a[80:83], v[28:31], 0
v_mov_b32_dpp v48, v52 quad_perm:[0,1,2,3] row_mask:0xf bank_mask:0x2
v_mfma_f32_16x16x32_bf16 v[60:63], a[84:87], v[32:35], v[60:63]
v_mov_b32_dpp v49, v53 quad_perm:[0,1,2,3] row_mask:0xf bank_mask:0x2
v_mfma_f32_16x16x32_bf16 v[60:63], a[88:91], v[36:39], v[60:63]
v_mov_b32_dpp v50, v54 quad_perm:[0,1,2,3] row_mask:0xf bank_mask:0x2
v_mfma_f32_16x16x32_bf16 v[60:63], a[92:95], v[40:43], v[60:63]
v_mov_b32_dpp v51, v55 quad_perm:[0,1,2,3] row_mask:0xf bank_mask:0x2
v_mfma_f32_16x16x32_bf16 v[52:55], a[96:99], v[28:31], 0
v_mov_b32_dpp v44, v56 quad_perm:[0,1,2,3] row_mask:0xf bank_mask:0x4
v_mfma_f32_16x16x32_bf16 v[52:55], a[100:103], v[32:35], v[52:55]
v_mov_b32_dpp v45, v57 quad_perm:[0,1,2,3] row_mask:0xf bank_mask:0x4
v_mfma_f32_16x16x32_bf16 v[52:55], a[104:107], v[36:39], v[52:55]
v_mov_b32_dpp v46, v58 quad_perm:[0,1,2,3] row_mask:0xf bank_mask:0x4
v_mfma_f32_16x16x32_bf16 v[52:55], a[108:111], v[40:43], v[52:55]
v_mov_b32_dpp v47, v59 quad_perm:[0,1,2,3] row_mask:0xf bank_mask:0x4
v_mfma_f32_16x16x32_bf16 v[56:59], a[112:115], v[28:31], 0
v_mov_b32_dpp v48, v60 quad_perm:[0,1,2,3] row_mask:0xf bank_mask:0x4
v_mfma_f32_16x16x32_bf16 v[56:59], a[116:119], v[32:35], v[56:59]
v_mov_b32_dpp v49, v61 quad_perm:[0,1,2,3] row_mask:0xf bank_mask:0x4
v_mfma_f32_16x16x32_bf16 v[56:59], a[120:123], v[36:39], v[56:59]
v_mov_b32_dpp v50, v62 quad_perm:[0,1,2,3] row_mask:0xf bank_mask:0x4
v_mfma_f32_16x16x32_bf16 v[56:59], a[124:127], v[40:43], v[56:59]
v_mov_b32_dpp v51, v63 quad_perm:[0,1,2,3] row_mask:0xf bank_mask:0x4
v_mov_b32_dpp v44, v52 quad_perm:[0,1,2,3] row_mask:0xf bank_mask:0x8
v_mov_b32_dpp v45, v53 quad_perm:[0,1,2,3] row_mask:0xf bank_mask:0x8
v_mov_b32_dpp v46, v54 quad_perm:[0,1,2,3] row_mask:0xf bank_mask:0x8
v_mov_b32_dpp v47, v55 quad_perm:[0,1,2,3] row_mask:0xf bank_mask:0x8
s_nop 0
s_nop 1
v_mov_b32_dpp v48, v56 quad_perm:[0,1,2,3] row_mask:0xf bank_mask:0x8
v_mov_b32_dpp v49, v57 quad_perm:[0,1,2,3] row_mask:0xf bank_mask:0x8
v_mov_b32_dpp v50, v58 quad_perm:[0,1,2,3] row_mask:0xf bank_mask:0x8
v_mov_b32_dpp v51, v59 quad_perm:[0,1,2,3] row_mask:0xf bank_mask:0x8
v_max3_f32 v32, v44, v45, v46
v_max3_f32 v33, v47, v48, v49
v_max3_f32 v32, v32, v50, v51
v_max_f32 v32, v32, v33
s_nop 1
v_max_f32_dpp v32, v32, v32 row_ror:4 row_mask:0xf bank_mask:0xf
s_nop 0
s_nop 0
v_max_f32_dpp v32, v32, v32 row_ror:8 row_mask:0xf bank_mask:0xf
v_mov_b32 v33, v32
s_nop 1
v_permlane16_swap_b32 v32, v33
v_max_f32 v32, v32, v33
v_mov_b32 v33, v32
s_nop 1
v_permlane32_swap_b32 v32, v33
v_max_f32 v32, v32, v33
v_sub_f32 v44, v44, v32
v_sub_f32 v45, v45, v32
v_sub_f32 v46, v46, v32
v_sub_f32 v47, v47, v32
v_sub_f32 v48, v48, v32
v_sub_f32 v49, v49, v32
v_sub_f32 v50, v50, v32
v_sub_f32 v51, v51, v32
ds_write_b32 v22, v32
v_exp_f32 v44, v44
v_exp_f32 v45, v45
v_exp_f32 v46, v46
v_exp_f32 v47, v47
v_exp_f32 v48, v48
v_exp_f32 v49, v49
v_exp_f32 v50, v50
v_exp_f32 v51, v51
v_cvt_pk_bf16_f32 v28, v44, v45
v_cvt_pk_bf16_f32 v29, v46, v47
v_cvt_pk_bf16_f32 v30, v48, v49
v_cvt_pk_bf16_f32 v31, v50, v51
s_nop 0
s_nop 0
v_mfma_f32_16x16x32_bf16 v[64:67], v[28:31], v[96:99], 0
v_mov_b32_dpp v52, v28 row_ror:12 row_mask:0xf bank_mask:0xf
v_mfma_f32_16x16x32_bf16 v[68:71], v[28:31], v[132:135], 0
v_mov_b32_dpp v53, v29 row_ror:12 row_mask:0xf bank_mask:0xf
v_mfma_f32_16x16x32_bf16 v[72:75], v[28:31], v[168:171], 0
v_mov_b32_dpp v54, v30 row_ror:12 row_mask:0xf bank_mask:0xf
v_mfma_f32_16x16x32_bf16 v[76:79], v[28:31], v[204:207], 0
v_mov_b32_dpp v55, v31 row_ror:12 row_mask:0xf bank_mask:0xf
v_add_f32 v34, v44, v45
v_add_f32 v33, v46, v47
v_mfma_f32_16x16x32_bf16 v[64:67], v[52:55], v[128:131], v[64:67]
v_mov_b32_dpp v56, v28 row_ror:8 row_mask:0xf bank_mask:0xf
v_mfma_f32_16x16x32_bf16 v[68:71], v[52:55], v[164:167], v[68:71]
v_mov_b32_dpp v57, v29 row_ror:8 row_mask:0xf bank_mask:0xf
v_mfma_f32_16x16x32_bf16 v[72:75], v[52:55], v[200:203], v[72:75]
v_mov_b32_dpp v58, v30 row_ror:8 row_mask:0xf bank_mask:0xf
v_mfma_f32_16x16x32_bf16 v[76:79], v[52:55], v[108:111], v[76:79]
v_mov_b32_dpp v59, v31 row_ror:8 row_mask:0xf bank_mask:0xf
v_add_f32 v34, v34, v48
v_add_f32 v33, v33, v49
v_mfma_f32_16x16x32_bf16 v[64:67], v[56:59], v[160:163], v[64:67]
v_mov_b32_dpp v60, v28 row_ror:4 row_mask:0xf bank_mask:0xf
v_mfma_f32_16x16x32_bf16 v[68:71], v[56:59], v[196:199], v[68:71]
v_mov_b32_dpp v61, v29 row_ror:4 row_mask:0xf bank_mask:0xf
v_mfma_f32_16x16x32_bf16 v[72:75], v[56:59], v[104:107], v[72:75]
v_mov_b32_dpp v62, v30 row_ror:4 row_mask:0xf bank_mask:0xf
v_mfma_f32_16x16x32_bf16 v[76:79], v[56:59], v[140:143], v[76:79]
v_mov_b32_dpp v63, v31 row_ror:4 row_mask:0xf bank_mask:0xf
v_add_f32 v34, v34, v50
v_add_f32 v33, v33, v51
v_mfma_f32_16x16x32_bf16 v[64:67], v[60:63], v[192:195], v[64:67]
v_add_f32 v34, v34, v33
s_waitcnt lgkmcnt(0)
v_mfma_f32_16x16x32_bf16 v[68:71], v[60:63], v[100:103], v[68:71]
s_barrier
ds_read_b128 v[36:39], v23
v_mfma_f32_16x16x32_bf16 v[72:75], v[60:63], v[136:139], v[72:75]
v_add_f32_dpp v34, v34, v34 row_ror:4 row_mask:0xf bank_mask:0xf
v_mfma_f32_16x16x32_bf16 v[76:79], v[60:63], v[172:175], v[76:79]
s_nop 0
v_add_f32_dpp v34, v34, v34 row_ror:8 row_mask:0xf bank_mask:0xf
v_mfma_f32_16x16x32_bf16 v[80:83], v[28:31], v[112:115], 0
v_mov_b32_e64 v33, v34
s_nop 1
v_permlane16_swap_b32 v34, v33
v_mfma_f32_16x16x32_bf16 v[80:83], v[52:55], v[144:147], v[80:83]
v_add_f32 v34, v34, v33
v_mov_b32 v33, v34
v_mfma_f32_16x16x32_bf16 v[80:83], v[56:59], v[176:179], v[80:83]
s_nop 0
v_permlane32_swap_b32 v34, v33
v_mfma_f32_16x16x32_bf16 v[80:83], v[60:63], v[208:211], v[80:83]
v_add_f32_e64 v34, v34, v33
ds_write_b32 v22, v34 offset:64
v_mfma_f32_16x16x32_bf16 v[84:87], v[28:31], v[148:151], 0
v_cndmask_b32 v64, v64, v68, s[28:29]
v_cndmask_b32 v65, v65, v69, s[28:29]
v_mfma_f32_16x16x32_bf16 v[84:87], v[52:55], v[180:183], v[84:87]
v_cndmask_b32 v66, v66, v70, s[28:29]
v_cndmask_b32 v67, v67, v71, s[28:29]
v_mfma_f32_16x16x32_bf16 v[84:87], v[56:59], v[212:215], v[84:87]
v_cndmask_b32 v64, v64, v72, s[30:31]
v_cndmask_b32 v65, v65, v73, s[30:31]
v_mfma_f32_16x16x32_bf16 v[84:87], v[60:63], v[116:119], v[84:87]
v_cndmask_b32 v66, v66, v74, s[30:31]
v_cndmask_b32 v67, v67, v75, s[30:31]
v_mfma_f32_16x16x32_bf16 v[88:91], v[28:31], v[184:187], 0
v_cndmask_b32 v64, v64, v76, s[36:37]
v_cndmask_b32 v65, v65, v77, s[36:37]
v_mfma_f32_16x16x32_bf16 v[88:91], v[52:55], v[216:219], v[88:91]
v_cndmask_b32 v66, v66, v78, s[36:37]
v_cndmask_b32 v67, v67, v79, s[36:37]
v_mfma_f32_16x16x32_bf16 v[88:91], v[56:59], v[120:123], v[88:91]
ds_write_b128 v11, v[64:67] offset:0
v_cndmask_b32 v80, v80, v84, s[28:29]
v_mfma_f32_16x16x32_bf16 v[88:91], v[60:63], v[152:155], v[88:91]
v_cndmask_b32 v81, v81, v85, s[28:29]
v_cndmask_b32 v82, v82, v86, s[28:29]
v_mfma_f32_16x16x32_bf16 v[92:95], v[28:31], v[220:223], 0
v_cndmask_b32 v83, v83, v87, s[28:29]
s_waitcnt lgkmcnt(2)
v_mfma_f32_16x16x32_bf16 v[92:95], v[52:55], v[124:127], v[92:95]
v_max3_f32 v40, v36, v37, v38
v_max_f32 v40, v40, v39
v_mfma_f32_16x16x32_bf16 v[92:95], v[56:59], v[156:159], v[92:95]
v_cndmask_b32 v80, v80, v88, s[30:31]
v_cndmask_b32 v81, v81, v89, s[30:31]
v_mfma_f32_16x16x32_bf16 v[92:95], v[60:63], v[188:191], v[92:95]
v_cndmask_b32 v82, v82, v90, s[30:31]
v_cndmask_b32 v83, v83, v91, s[30:31]
s_nop 0
s_nop 4
v_cndmask_b32 v80, v80, v92, s[36:37]
v_cndmask_b32 v81, v81, v93, s[36:37]
v_cndmask_b32 v82, v82, v94, s[36:37]
v_cndmask_b32 v83, v83, v95, s[36:37]
ds_write_b128 v11, v[80:83] offset:1024
v_sub_f32 v36, v36, v40
v_sub_f32 v37, v37, v40
v_sub_f32 v38, v38, v40
v_sub_f32 v39, v39, v40
v_exp_f32 v36, v36
v_exp_f32 v37, v37
v_exp_f32 v38, v38
v_exp_f32 v39, v39
s_branch L_comb
L_final:
s_or_b32 s3, s56, s58
s_cmp_lg_u32 s3, 0
s_cbranch_scc1 L_done
s_barrier
s_sleep 7
L_gf50:
buffer_load_dwordx4 v[32:35], v7, s[52:55], s74 offen sc1
buffer_load_dwordx4 v[36:39], v7, s[52:55], s78 offen sc1
s_waitcnt vmcnt(1)
v_mfma_f32_16x16x32_bf16 v[40:43], v[12:15], v[32:35], v[16:19]
s_waitcnt vmcnt(0)
v_mfma_f32_16x16x32_bf16 v[40:43], v[12:15], v[36:39], v[40:43]
L_gfck52:
s_nop 7
v_cmp_u_f32 vcc, v40, v40
s_cbranch_vccz L_gfok51
s_sub_u32 s62, s62, 1
s_cbranch_scc0 L_gf50
s_mov_b32 s62, 0
L_gfok51:
v_cvt_pk_bf16_f32 v28, v40, v41
v_cvt_pk_bf16_f32 v29, v42, v43
s_lshl_b32 s3, s57, 10
s_lshl_b32 s26, s59, 8
s_add_u32 s3, s3, s26
s_lshl_b32 s26, s59, 9
s_add_u32 s26, s26, 147456
s_sub_u32 s3, s3, s26
v_add_u32 v30, s3, v1
s_mov_b32 exec_lo, 0xffffffff
s_mov_b32 exec_hi, 0x0
global_store_dwordx2 v30, v[28:29], s[20:21]
s_cmp_lg_u32 s57, 0
s_cbranch_scc1 L_sk54
v_mov_b32 v30, 917504
v_mov_b32_e64 v31, s22
s_mov_b32 exec_lo, 0x1
s_mov_b32 exec_hi, 0x0
global_store_dword v30, v31, s[24:25] sc1
L_sk54:
s_mov_b64 exec, -1
s_branch L_done
L_cen2:
s_mov_b32 s3, 918528
buffer_load_dwordx4 v[32:35], v26, s[52:55], s3 offen sc1
buffer_load_dwordx4 v[36:39], v26, s[52:55], s3 offen offset:1024 sc1
s_waitcnt vmcnt(0)
v_xor_b32 v32, s22, v32
v_xor_b32 v33, s23, v33
v_xor_b32 v34, s22, v34
v_xor_b32 v35, s23, v35
v_xor_b32 v36, s22, v36
v_xor_b32 v37, s23, v37
v_xor_b32 v38, s22, v38
v_xor_b32_e64 v39, s23, v39
v_or3_b32 v40, v33, v35, v37
v_or3_b32 v42, v32, v34, v36
v_or_b32 v40, v40, v39
v_and_b32 v40, -16, v40
v_or3_b32 v40, v40, v42, v38
v_cmp_ne_u32_e64 vcc, 0, v40
s_cbranch_vccz L_cen2_ok
s_sub_u32 s62, s62, 1
s_cbranch_scc0 L_cen2
s_mov_b32 s62, 0
L_cen2_ok:
s_mov_b32 s11, 0
s_branch L_cen2_back
L_done:
L_end:
s_endpgm
L_ps11:
s_nop 7
buffer_store_dword v44, v21, s[52:55], s75 offen sc1
s_branch L_pe12
L_ps14:
s_nop 7
buffer_store_dwordx2 v[40:41], v46, s[52:55], s67 offen sc1
s_branch L_pe15
L_ps33:
s_nop 7
buffer_store_short v28, v10, s[52:55], s69 offen sc1
s_branch L_pe34
L_ps45:
s_nop 7
buffer_store_dword v48, v5, s[52:55], s3 offen sc1
s_branch L_pe46
.section .rodata,"a"
.p2align 6
.amdhsa_kernel interleave_layers__gqa_block_cached__dense_activation_silu__decode_kernel
  .amdhsa_next_free_vgpr 512
  .amdhsa_next_free_sgpr 102
  .amdhsa_accum_offset 256
  .amdhsa_group_segment_fixed_size 0
  .amdhsa_kernarg_size 88
  .amdhsa_user_sgpr_count 2
  .amdhsa_user_sgpr_kernarg_segment_ptr 1
  .amdhsa_system_sgpr_workgroup_id_x 1
.end_amdhsa_kernel
```
